```python
import torch

def _softmax(x, axis=-1):
    return torch.softmax(x, dim=axis)
def _gelu(x):
    return torch.nn.functional.gelu(x, approximate="tanh")
def _silu(x):
    return torch.nn.functional.silu(x)
def _sigmoid(x):
    return torch.sigmoid(x)
def _layernorm(x, axis=-1, eps=1e-5):
    m = x.mean(dim=axis, keepdim=True)
    v = x.var(dim=axis, keepdim=True, unbiased=False)
    return (x - m) / torch.sqrt(v + eps)
def _scatter_add(tgt, idx, src, axis=0):
    return tgt.clone().index_add_(axis, idx, src)
def _segment_sum(src, seg, n):
    out = torch.zeros((n,) + src.shape[1:], dtype=src.dtype)
    return out.index_add_(0, seg, src)
def _pad(x, pw):
    flat = tuple(v for pair in reversed(pw) for v in pair)
    return torch.nn.functional.pad(x, flat)

kernel_name = 'standalone__mha_softmax__near_ridge'

def setup_inputs():

    _w = (lambda a: (lambda t: t.to(torch.bfloat16) if t.is_floating_point() else t)(torch.as_tensor(a)))
    B, H, Sq, Sk, D = 8, 32, 240, 2048, 128
    return {
        "q": _w((lambda *s: torch.randn(*s, dtype=torch.bfloat16) * 0.8)(B, H, Sq, D)),
        "k": _w((lambda *s: torch.randn(*s, dtype=torch.bfloat16) * 0.8)(B, H, Sk, D)),
        "v": _w((lambda *s: torch.randn(*s, dtype=torch.bfloat16) * 0.05)(B, H, Sk, D)),
    }

def reference(q, k, v):
    scale = q.shape[-1] ** -0.5
    scores = torch.einsum("bhqd,bhkd->bhqk", q, k) * scale
    p = _softmax(scores, axis=-1)
    return torch.einsum("bhqk,bhkd->bhqd", p, v)
```

```asm
; @launch grid=(256,1,1) block=(256,1,1) lds=163840
.amdgcn_target "amdgcn-amd-amdhsa--gfx950"
.text
.globl standalone__mha_softmax__near_ridge_kernel
.p2align 8
.type standalone__mha_softmax__near_ridge_kernel,@function
standalone__mha_softmax__near_ridge_kernel:
    s_cmp_ge_u32 s2, 256
    s_cbranch_scc1 L_end
    s_load_dwordx4 s[28:31], s[0:1], 0
    s_load_dwordx4 s[32:35], s[0:1], 16
    s_getpc_b64 s[60:61]
L_pc:
    s_lshr_b32 s62, s2, 3
    s_lshl_b32 s63, s2, 1
    s_xor_b32 s62, s62, s63
    s_and_b32 s62, s62, 15
    s_lshl_b32 s62, s62, 12
    s_min_u32 s62, s62, L_slow-L_pc-4096
    s_add_u32 s60, s60, s62
    s_addc_u32 s61, s61, 0
    v_lshlrev_b32 v251, 4, v0
    global_load_dwordx4 v[252:255], v251, s[60:61]
    v_lshrrev_b32 v228, 6, v0
    v_and_b32 v214, 63, v0
    v_readfirstlane_b32 s20, v228
    v_and_b32 v224, 15, v214
    v_lshrrev_b32 v225, 4, v214
    v_xor_b32 v226, v224, v225
    v_lshlrev_b32 v226, 4, v226
    v_lshl_add_u32 v208, v225, 8, v226
    v_xor_b32 v209, 64, v208
    v_xor_b32 v210, 128, v208
    v_xor_b32 v211, 192, v208
    v_lshlrev_b32 v226, 1, v225
    v_xor_b32 v226, v226, v224
    v_lshlrev_b32 v226, 4, v226
    v_lshl_add_u32 v212, v225, 8, v226
    v_xor_b32 v213, 128, v212
    s_mul_i32 s38, s2, 61440
    s_lshl_b32 s39, s2, 19
    s_lshl_b32 s43, s20, 14
    s_lshl_b32 s21, s20, 12
    s_add_u32 s42, s43, 98304
    s_waitcnt lgkmcnt(0)
    s_add_u32 s12, s28, s38
    s_addc_u32 s13, s29, 0
    s_mov_b32 s14, 61440
    s_mov_b32 s15, 0x20000
    s_mov_b32 m0, s42
    s_add_u32 s26, s43, 4096
    buffer_load_dwordx4 v208, s[12:15], s43 offen offset:0 sc0 sc1 nt lds
    buffer_load_dwordx4 v209, s[12:15], s43 offen offset:1024 sc0 sc1 nt lds
    buffer_load_dwordx4 v210, s[12:15], s43 offen offset:2048 sc0 sc1 nt lds
    buffer_load_dwordx4 v211, s[12:15], s43 offen offset:3072 sc0 sc1 nt lds
    s_add_u32 s4, s30, s39
    s_addc_u32 s5, s31, 0
    s_mov_b32 s6, 524288
    s_mov_b32 s7, 0x20000
    s_mov_b32 m0, s21
    s_nop 0
    buffer_load_dwordx4 v208, s[4:7], s21 offen offset:0 sc0 sc1 nt lds
    buffer_load_dwordx4 v209, s[4:7], s21 offen offset:1024 sc0 sc1 nt lds
    buffer_load_dwordx4 v210, s[4:7], s21 offen offset:2048 sc0 sc1 nt lds
    buffer_load_dwordx4 v211, s[4:7], s21 offen offset:3072 sc0 sc1 nt lds
    s_add_u32 m0, s42, 4096
    s_nop 0
    buffer_load_dwordx4 v208, s[12:15], s26 offen offset:0 sc0 sc1 nt lds
    buffer_load_dwordx4 v209, s[12:15], s26 offen offset:1024 sc0 sc1 nt lds
    buffer_load_dwordx4 v210, s[12:15], s26 offen offset:2048 sc0 sc1 nt lds
    buffer_load_dwordx4 v211, s[12:15], s26 offen offset:3072 sc0 sc1 nt lds
    s_add_u32 s8, s32, s39
    s_addc_u32 s9, s33, 0
    s_mov_b32 s10, 524288
    s_mov_b32 s11, 0x20000
    s_add_u32 s16, s34, s38
    s_addc_u32 s17, s35, 0
    s_mov_b32 s18, 61440
    s_mov_b32 s19, 0x20000
    s_cmp_eq_u32 s20, 3
    s_cbranch_scc1 L_proB
L_proA:
    v_xor_b32 v226, v224, v225
    v_lshlrev_b32 v226, 4, v226
    v_lshl_add_u32 v192, v224, 8, v226
    v_xor_b32 v193, 64, v192
    v_xor_b32 v194, 128, v192
    v_xor_b32 v195, 192, v192
    v_add_u32 v248, s42, v192
    v_add_u32 v249, s42, v193
    v_add_u32 v250, s42, v194
    v_add_u32 v251, s42, v195
    v_lshrrev_b32 v226, 2, v214
    v_and_b32 v227, 7, v226
    v_lshlrev_b32 v226, 8, v226
    v_lshl_add_u32 v226, v227, 5, v226
    v_and_b32 v227, 3, v214
    v_lshl_add_u32 v196, v227, 3, v226
    v_xor_b32 v197, 32, v196
    v_xor_b32 v198, 64, v196
    v_xor_b32 v199, 96, v196
    v_xor_b32 v200, 128, v196
    v_xor_b32 v201, 160, v196
    v_xor_b32 v202, 192, v196
    v_xor_b32 v203, 224, v196
    v_cmp_eq_u32 vcc, 0, v227
    v_mov_b32 v226, 0xeeeeeeee
    v_mov_b32 v228, 0x44444444
    v_cndmask_b32 v220, v226, v228, vcc
    v_cmp_gt_u32 vcc, 2, v227
    v_mov_b32 v226, 0x3f803f80
    s_mov_b32 s36, 0x3e0293ee
    s_mov_b32 s37, 0x3e0293ee
    v_cndmask_b32 v204, 0, v226, vcc
    v_cndmask_b32 v205, 0, v226, vcc
    v_cndmask_b32 v206, 0, v226, vcc
    v_cndmask_b32 v207, 0, v226, vcc
    s_lshl_b32 s38, s20, 13
    s_add_u32 s38, s38, 131072
    v_and_b32 v244, 15, v214
    v_lshrrev_b32 v245, 4, v214
    v_lshrrev_b32 v246, 1, v245
    v_and_b32 v247, 7, v244
    v_xor_b32 v246, v246, v247
    v_lshlrev_b32 v246, 4, v246
    v_lshl_add_u32 v246, v244, 8, v246
    v_and_b32 v247, 1, v245
    v_lshl_add_u32 v246, v247, 3, v246
    v_add_u32 v232, s38, v246
    v_xor_b32 v233, 32, v232
    v_xor_b32 v234, 64, v232
    v_xor_b32 v235, 96, v232
    v_xor_b32 v236, 128, v232
    v_xor_b32 v237, 160, v232
    v_xor_b32 v238, 192, v232
    v_xor_b32 v239, 224, v232
    v_xor_b32 v246, v244, v245
    v_lshlrev_b32 v246, 4, v246
    v_lshl_add_u32 v246, v245, 8, v246
    v_add_u32 v216, s38, v246
    v_xor_b32 v240, 64, v216
    v_lshlrev_b32 v217, 4, v214
    v_mov_b32 v176, 0
    v_mov_b32 v177, 0
    v_mov_b32 v178, 0
    v_mov_b32 v179, 0
    v_mov_b32 v180, 0
    v_mov_b32 v181, 0
    v_mov_b32 v182, 0
    v_mov_b32 v183, 0
    v_mov_b32 v184, 0
    v_mov_b32 v185, 0
    v_mov_b32 v186, 0
    v_mov_b32 v187, 0
    v_mov_b32 v188, 0
    v_mov_b32 v189, 0
    v_mov_b32 v190, 0
    v_mov_b32 v191, 0
    s_mov_b32 s26, 0
    s_mov_b32 s63, 0xffff0000
    s_mov_b32 s27, 0x07060302
    s_waitcnt vmcnt(8)
    s_add_u32 m0, s21, 16384
    s_add_u32 s38, s21, 0
    buffer_load_dwordx4 v212, s[8:11], s38 offen offset:0 sc0 sc1 nt lds
    buffer_load_dwordx4 v213, s[8:11], s38 offen offset:1024 sc0 sc1 nt lds
    buffer_load_dwordx4 v212, s[8:11], s38 offen offset:2048 sc0 sc1 nt lds
    buffer_load_dwordx4 v213, s[8:11], s38 offen offset:3072 sc0 sc1 nt lds
    ds_read_b128 v[0:3], v248 offset:0
    ds_read_b128 v[4:7], v249 offset:0
    ds_read_b128 v[8:11], v250 offset:0
    ds_read_b128 v[12:15], v251 offset:0
    s_waitcnt lgkmcnt(3)
    v_lshlrev_b32 v224, 16, v0
    v_and_b32 v225, s63, v0
    v_pk_mul_f32 v[224:225], v[224:225], s[36:37]
    v_cvt_pk_bf16_f32 v224, v224, v225
    v_accvgpr_write_b32 a0, v224
    v_lshlrev_b32 v226, 16, v1
    v_and_b32 v227, s63, v1
    v_pk_mul_f32 v[226:227], v[226:227], s[36:37]
    v_cvt_pk_bf16_f32 v226, v226, v227
    v_accvgpr_write_b32 a1, v226
    v_lshlrev_b32 v228, 16, v2
    v_and_b32 v229, s63, v2
    v_pk_mul_f32 v[228:229], v[228:229], s[36:37]
    v_cvt_pk_bf16_f32 v228, v228, v229
    v_accvgpr_write_b32 a2, v228
    v_lshlrev_b32 v230, 16, v3
    v_and_b32 v231, s63, v3
    v_pk_mul_f32 v[230:231], v[230:231], s[36:37]
    v_cvt_pk_bf16_f32 v230, v230, v231
    v_accvgpr_write_b32 a3, v230
    s_waitcnt lgkmcnt(2)
    v_lshlrev_b32 v224, 16, v4
    v_and_b32 v225, s63, v4
    v_pk_mul_f32 v[224:225], v[224:225], s[36:37]
    v_cvt_pk_bf16_f32 v224, v224, v225
    v_accvgpr_write_b32 a4, v224
    v_lshlrev_b32 v226, 16, v5
    v_and_b32 v227, s63, v5
    v_pk_mul_f32 v[226:227], v[226:227], s[36:37]
    v_cvt_pk_bf16_f32 v226, v226, v227
    v_accvgpr_write_b32 a5, v226
    v_lshlrev_b32 v228, 16, v6
    v_and_b32 v229, s63, v6
    v_pk_mul_f32 v[228:229], v[228:229], s[36:37]
    v_cvt_pk_bf16_f32 v228, v228, v229
    v_accvgpr_write_b32 a6, v228
    v_lshlrev_b32 v230, 16, v7
    v_and_b32 v231, s63, v7
    v_pk_mul_f32 v[230:231], v[230:231], s[36:37]
    v_cvt_pk_bf16_f32 v230, v230, v231
    v_accvgpr_write_b32 a7, v230
    s_waitcnt lgkmcnt(1)
    v_lshlrev_b32 v224, 16, v8
    v_and_b32 v225, s63, v8
    v_pk_mul_f32 v[224:225], v[224:225], s[36:37]
    v_cvt_pk_bf16_f32 v224, v224, v225
    v_accvgpr_write_b32 a8, v224
    v_lshlrev_b32 v226, 16, v9
    v_and_b32 v227, s63, v9
    v_pk_mul_f32 v[226:227], v[226:227], s[36:37]
    v_cvt_pk_bf16_f32 v226, v226, v227
    v_accvgpr_write_b32 a9, v226
    v_lshlrev_b32 v228, 16, v10
    v_and_b32 v229, s63, v10
    v_pk_mul_f32 v[228:229], v[228:229], s[36:37]
    v_cvt_pk_bf16_f32 v228, v228, v229
    v_accvgpr_write_b32 a10, v228
    v_lshlrev_b32 v230, 16, v11
    v_and_b32 v231, s63, v11
    v_pk_mul_f32 v[230:231], v[230:231], s[36:37]
    v_cvt_pk_bf16_f32 v230, v230, v231
    v_accvgpr_write_b32 a11, v230
    s_waitcnt lgkmcnt(0)
    v_lshlrev_b32 v224, 16, v12
    v_and_b32 v225, s63, v12
    v_pk_mul_f32 v[224:225], v[224:225], s[36:37]
    v_cvt_pk_bf16_f32 v224, v224, v225
    v_accvgpr_write_b32 a12, v224
    v_lshlrev_b32 v226, 16, v13
    v_and_b32 v227, s63, v13
    v_pk_mul_f32 v[226:227], v[226:227], s[36:37]
    v_cvt_pk_bf16_f32 v226, v226, v227
    v_accvgpr_write_b32 a13, v226
    v_lshlrev_b32 v228, 16, v14
    v_and_b32 v229, s63, v14
    v_pk_mul_f32 v[228:229], v[228:229], s[36:37]
    v_cvt_pk_bf16_f32 v228, v228, v229
    v_accvgpr_write_b32 a14, v228
    v_lshlrev_b32 v230, 16, v15
    v_and_b32 v231, s63, v15
    v_pk_mul_f32 v[230:231], v[230:231], s[36:37]
    v_cvt_pk_bf16_f32 v230, v230, v231
    v_accvgpr_write_b32 a15, v230
    s_waitcnt vmcnt(8)
    s_barrier
    ds_read_b128 a[64:67], v192 offset:0
    ds_read_b128 a[68:71], v193 offset:0
    ds_read_b128 a[72:75], v194 offset:0
    ds_read_b128 a[76:79], v195 offset:0
    ds_read_b128 a[80:83], v192 offset:4096
    ds_read_b128 a[84:87], v193 offset:4096
    ds_read_b128 a[88:91], v194 offset:4096
    ds_read_b128 a[92:95], v195 offset:4096
    ds_read_b128 a[96:99], v192 offset:8192
    ds_read_b128 a[100:103], v193 offset:8192
    ds_read_b128 a[104:107], v194 offset:8192
    ds_read_b128 a[108:111], v195 offset:8192
    ds_read_b128 a[112:115], v192 offset:12288
    ds_read_b128 a[116:119], v193 offset:12288
    ds_read_b128 a[120:123], v194 offset:12288
    ds_read_b128 a[124:127], v195 offset:12288
    s_add_u32 m0, s42, 8192
    s_add_u32 s38, s43, 8192
    buffer_load_dwordx4 v208, s[12:15], s38 offen offset:0 sc0 sc1 nt lds
    buffer_load_dwordx4 v209, s[12:15], s38 offen offset:1024 sc0 sc1 nt lds
    buffer_load_dwordx4 v210, s[12:15], s38 offen offset:2048 sc0 sc1 nt lds
    buffer_load_dwordx4 v211, s[12:15], s38 offen offset:3072 sc0 sc1 nt lds
    s_waitcnt vmcnt(8)
    ds_read_b128 v[32:35], v248 offset:4096
    ds_read_b128 v[36:39], v249 offset:4096
    ds_read_b128 v[40:43], v250 offset:4096
    ds_read_b128 v[44:47], v251 offset:4096
    s_add_u32 m0, s42, 12288
    s_add_u32 s38, s43, 12288
    buffer_load_dwordx4 v208, s[12:15], s38 offen offset:0 sc0 sc1 nt lds
    buffer_load_dwordx4 v209, s[12:15], s38 offen offset:1024 sc0 sc1 nt lds
    buffer_load_dwordx4 v210, s[12:15], s38 offen offset:2048 sc0 sc1 nt lds
    buffer_load_dwordx4 v211, s[12:15], s38 offen offset:3072 sc0 sc1 nt lds
    s_waitcnt lgkmcnt(0)
    v_mfma_f32_16x16x32_bf16 v[128:131], a[64:67], a[0:3], 0
    v_lshlrev_b32 v224, 16, v32
    v_and_b32 v225, s63, v32
    v_mul_f32 v224, s36, v224
    v_mul_f32 v225, s36, v225
    v_cvt_pk_bf16_f32 v224, v224, v225
    v_accvgpr_write_b32 a16, v224
    v_mfma_f32_16x16x32_bf16 v[128:131], a[68:71], a[4:7], v[128:131]
    v_lshlrev_b32 v226, 16, v33
    v_and_b32 v227, s63, v33
    v_mul_f32 v226, s36, v226
    v_mul_f32 v227, s36, v227
    v_cvt_pk_bf16_f32 v226, v226, v227
    v_accvgpr_write_b32 a17, v226
    v_mfma_f32_16x16x32_bf16 v[128:131], a[72:75], a[8:11], v[128:131]
    v_lshlrev_b32 v228, 16, v34
    v_and_b32 v229, s63, v34
    v_mul_f32 v228, s36, v228
    v_mul_f32 v229, s36, v229
    v_cvt_pk_bf16_f32 v228, v228, v229
    v_accvgpr_write_b32 a18, v228
    v_mfma_f32_16x16x32_bf16 v[128:131], a[76:79], a[12:15], v[128:131]
    v_lshlrev_b32 v230, 16, v35
    v_and_b32 v231, s63, v35
    v_mul_f32 v230, s36, v230
    v_mul_f32 v231, s36, v231
    v_cvt_pk_bf16_f32 v230, v230, v231
    v_accvgpr_write_b32 a19, v230
    v_mfma_f32_16x16x32_bf16 v[132:135], a[80:83], a[0:3], 0
    v_lshlrev_b32 v224, 16, v36
    v_and_b32 v225, s63, v36
    v_mul_f32 v224, s36, v224
    v_mul_f32 v225, s36, v225
    v_cvt_pk_bf16_f32 v224, v224, v225
    v_accvgpr_write_b32 a20, v224
    v_mfma_f32_16x16x32_bf16 v[132:135], a[84:87], a[4:7], v[132:135]
    v_lshlrev_b32 v226, 16, v37
    v_and_b32 v227, s63, v37
    v_mul_f32 v226, s36, v226
    v_mul_f32 v227, s36, v227
    v_cvt_pk_bf16_f32 v226, v226, v227
    v_accvgpr_write_b32 a21, v226
    v_mfma_f32_16x16x32_bf16 v[132:135], a[88:91], a[8:11], v[132:135]
    v_lshlrev_b32 v228, 16, v38
    v_and_b32 v229, s63, v38
    v_mul_f32 v228, s36, v228
    v_mul_f32 v229, s36, v229
    v_cvt_pk_bf16_f32 v228, v228, v229
    v_accvgpr_write_b32 a22, v228
    v_mfma_f32_16x16x32_bf16 v[132:135], a[92:95], a[12:15], v[132:135]
    v_lshlrev_b32 v230, 16, v39
    v_and_b32 v231, s63, v39
    v_mul_f32 v230, s36, v230
    v_mul_f32 v231, s36, v231
    v_cvt_pk_bf16_f32 v230, v230, v231
    v_accvgpr_write_b32 a23, v230
    v_mfma_f32_16x16x32_bf16 v[136:139], a[96:99], a[0:3], 0
    v_lshlrev_b32 v224, 16, v40
    v_and_b32 v225, s63, v40
    v_mul_f32 v224, s36, v224
    v_mul_f32 v225, s36, v225
    v_cvt_pk_bf16_f32 v224, v224, v225
    v_accvgpr_write_b32 a24, v224
    v_mfma_f32_16x16x32_bf16 v[136:139], a[100:103], a[4:7], v[136:139]
    v_lshlrev_b32 v226, 16, v41
    v_and_b32 v227, s63, v41
    v_mul_f32 v226, s36, v226
    v_mul_f32 v227, s36, v227
    v_cvt_pk_bf16_f32 v226, v226, v227
    v_accvgpr_write_b32 a25, v226
    v_mfma_f32_16x16x32_bf16 v[136:139], a[104:107], a[8:11], v[136:139]
    v_lshlrev_b32 v228, 16, v42
    v_and_b32 v229, s63, v42
    v_mul_f32 v228, s36, v228
    v_mul_f32 v229, s36, v229
    v_cvt_pk_bf16_f32 v228, v228, v229
    v_accvgpr_write_b32 a26, v228
    v_mfma_f32_16x16x32_bf16 v[136:139], a[108:111], a[12:15], v[136:139]
    v_lshlrev_b32 v230, 16, v43
    v_and_b32 v231, s63, v43
    v_mul_f32 v230, s36, v230
    v_mul_f32 v231, s36, v231
    v_cvt_pk_bf16_f32 v230, v230, v231
    v_accvgpr_write_b32 a27, v230
    v_mfma_f32_16x16x32_bf16 v[140:143], a[112:115], a[0:3], 0
    v_lshlrev_b32 v224, 16, v44
    v_and_b32 v225, s63, v44
    v_mul_f32 v224, s36, v224
    v_mul_f32 v225, s36, v225
    v_cvt_pk_bf16_f32 v224, v224, v225
    v_accvgpr_write_b32 a28, v224
    v_mfma_f32_16x16x32_bf16 v[140:143], a[116:119], a[4:7], v[140:143]
    v_lshlrev_b32 v226, 16, v45
    v_and_b32 v227, s63, v45
    v_mul_f32 v226, s36, v226
    v_mul_f32 v227, s36, v227
    v_cvt_pk_bf16_f32 v226, v226, v227
    v_accvgpr_write_b32 a29, v226
    v_mfma_f32_16x16x32_bf16 v[140:143], a[120:123], a[8:11], v[140:143]
    v_lshlrev_b32 v228, 16, v46
    v_and_b32 v229, s63, v46
    v_mul_f32 v228, s36, v228
    v_mul_f32 v229, s36, v229
    v_cvt_pk_bf16_f32 v228, v228, v229
    v_accvgpr_write_b32 a30, v228
    v_mfma_f32_16x16x32_bf16 v[140:143], a[124:127], a[12:15], v[140:143]
    v_lshlrev_b32 v230, 16, v47
    v_and_b32 v231, s63, v47
    v_mul_f32 v230, s36, v230
    v_mul_f32 v231, s36, v231
    v_cvt_pk_bf16_f32 v230, v230, v231
    v_accvgpr_write_b32 a31, v230
    v_max3_f32 v241, v128, v129, v130
    v_max3_f32 v241, v241, v131, v132
    v_max3_f32 v241, v241, v133, v134
    v_max3_f32 v241, v241, v135, v136
    v_max3_f32 v241, v241, v137, v138
    v_max3_f32 v241, v241, v139, v140
    v_max3_f32 v241, v241, v141, v142
    v_max_f32 v241, v241, v143
    v_mov_b32 v242, v241
    s_nop 1
    v_permlane32_swap_b32 v241, v242
    v_max_f32 v241, v241, v242
    v_mov_b32 v242, v241
    s_nop 1
    v_permlane16_swap_b32 v241, v242
    v_max_f32 v241, v241, v242
    v_sub_f32 v128, v128, v241
    v_sub_f32 v129, v129, v241
    v_sub_f32 v130, v130, v241
    v_sub_f32 v131, v131, v241
    v_sub_f32 v132, v132, v241
    v_sub_f32 v133, v133, v241
    v_sub_f32 v134, v134, v241
    v_sub_f32 v135, v135, v241
    v_sub_f32 v136, v136, v241
    v_sub_f32 v137, v137, v241
    v_sub_f32 v138, v138, v241
    v_sub_f32 v139, v139, v241
    v_sub_f32 v140, v140, v241
    v_sub_f32 v141, v141, v241
    v_sub_f32 v142, v142, v241
    v_sub_f32 v143, v143, v241
    v_exp_f32 v128, v128
    v_exp_f32 v129, v129
    v_exp_f32 v130, v130
    v_perm_b32 v128, v129, v128, s27
    v_exp_f32 v131, v131
    v_exp_f32 v132, v132
    v_perm_b32 v129, v131, v130, s27
    v_exp_f32 v133, v133
    v_exp_f32 v134, v134
    v_perm_b32 v130, v133, v132, s27
    v_exp_f32 v135, v135
    v_exp_f32 v136, v136
    v_perm_b32 v131, v135, v134, s27
    v_exp_f32 v137, v137
    v_exp_f32 v138, v138
    v_perm_b32 v132, v137, v136, s27
    v_exp_f32 v139, v139
    v_exp_f32 v140, v140
    v_perm_b32 v133, v139, v138, s27
    v_exp_f32 v141, v141
    v_exp_f32 v142, v142
    v_perm_b32 v134, v141, v140, s27
    v_exp_f32 v143, v143
    v_sub_f32 v160, 0, v241
    v_sub_f32 v161, 0, v241
    v_sub_f32 v162, 0, v241
    v_sub_f32 v163, 0, v241
    v_perm_b32 v135, v143, v142, s27
    s_waitcnt vmcnt(8)
    s_barrier
    s_add_u32 m0, s21, 32768
    s_add_u32 s38, s21, 16384
    buffer_load_dwordx4 v208, s[4:7], s38 offen offset:0 sc0 sc1 nt lds
    buffer_load_dwordx4 v209, s[4:7], s38 offen offset:1024 sc0 sc1 nt lds
    buffer_load_dwordx4 v210, s[4:7], s38 offen offset:2048 sc0 sc1 nt lds
    buffer_load_dwordx4 v211, s[4:7], s38 offen offset:3072 sc0 sc1 nt lds
    ds_read_b64_tr_b16 a[128:129], v196 offset:16384
    ds_read_b64_tr_b16 a[130:131], v196 offset:20480
    ds_read_b64_tr_b16 a[132:133], v196 offset:24576
    ds_read_b64_tr_b16 a[134:135], v196 offset:28672
    ds_read_b64_tr_b16 a[136:137], v197 offset:16384
    ds_read_b64_tr_b16 a[138:139], v197 offset:20480
    ds_read_b64_tr_b16 a[140:141], v197 offset:24576
    ds_read_b64_tr_b16 a[142:143], v197 offset:28672
    ds_read_b64_tr_b16 a[144:145], v198 offset:16384
    ds_read_b64_tr_b16 a[146:147], v198 offset:20480
    ds_read_b64_tr_b16 a[148:149], v198 offset:24576
    ds_read_b64_tr_b16 a[150:151], v198 offset:28672
    ds_read_b64_tr_b16 a[152:153], v199 offset:16384
    ds_read_b64_tr_b16 a[154:155], v199 offset:20480
    ds_read_b64_tr_b16 a[156:157], v199 offset:24576
    ds_read_b64_tr_b16 a[158:159], v199 offset:28672
    ds_read_b64_tr_b16 a[160:161], v200 offset:16384
    ds_read_b64_tr_b16 a[162:163], v200 offset:20480
    ds_read_b64_tr_b16 a[164:165], v200 offset:24576
    ds_read_b64_tr_b16 a[166:167], v200 offset:28672
    ds_read_b64_tr_b16 a[168:169], v201 offset:16384
    ds_read_b64_tr_b16 a[170:171], v201 offset:20480
    ds_read_b64_tr_b16 a[172:173], v201 offset:24576
    ds_read_b64_tr_b16 a[174:175], v201 offset:28672
    ds_read_b64_tr_b16 a[176:177], v202 offset:16384
    ds_read_b64_tr_b16 a[178:179], v202 offset:20480
    ds_read_b64_tr_b16 a[180:181], v202 offset:24576
    ds_read_b64_tr_b16 a[182:183], v202 offset:28672
    ds_read_b64_tr_b16 a[184:185], v203 offset:16384
    ds_read_b64_tr_b16 a[186:187], v203 offset:20480
    ds_read_b64_tr_b16 a[188:189], v203 offset:24576
    ds_read_b64_tr_b16 a[190:191], v203 offset:28672
    s_waitcnt vmcnt(8)
    ds_read_b128 v[64:67], v248 offset:8192
    ds_read_b128 v[68:71], v249 offset:8192
    ds_read_b128 v[72:75], v250 offset:8192
    ds_read_b128 v[76:79], v251 offset:8192
    s_add_u32 m0, s21, 49152
    s_add_u32 s38, s21, 16384
    buffer_load_dwordx4 v212, s[8:11], s38 offen offset:0 sc0 sc1 nt lds
    buffer_load_dwordx4 v213, s[8:11], s38 offen offset:1024 sc0 sc1 nt lds
    buffer_load_dwordx4 v212, s[8:11], s38 offen offset:2048 sc0 sc1 nt lds
    buffer_load_dwordx4 v213, s[8:11], s38 offen offset:3072 sc0 sc1 nt lds
    s_waitcnt lgkmcnt(0)
    v_mfma_f32_16x16x32_bf16 v[144:147], a[64:67], a[16:19], 0
    v_lshlrev_b32 v224, 16, v64
    v_and_b32 v225, s63, v64
    v_mul_f32 v224, s36, v224
    v_mul_f32 v225, s36, v225
    v_cvt_pk_bf16_f32 v224, v224, v225
    v_accvgpr_write_b32 a32, v224
    v_mfma_f32_16x16x32_bf16 v[144:147], a[68:71], a[20:23], v[144:147]
    v_lshlrev_b32 v226, 16, v65
    v_and_b32 v227, s63, v65
    v_mul_f32 v226, s36, v226
    v_mul_f32 v227, s36, v227
    v_cvt_pk_bf16_f32 v226, v226, v227
    v_accvgpr_write_b32 a33, v226
    v_mfma_f32_16x16x32_bf16 v[144:147], a[72:75], a[24:27], v[144:147]
    v_lshlrev_b32 v228, 16, v66
    v_and_b32 v229, s63, v66
    v_mul_f32 v228, s36, v228
    v_mul_f32 v229, s36, v229
    v_cvt_pk_bf16_f32 v228, v228, v229
    v_accvgpr_write_b32 a34, v228
    v_mfma_f32_16x16x32_bf16 v[144:147], a[76:79], a[28:31], v[144:147]
    v_lshlrev_b32 v230, 16, v67
    v_and_b32 v231, s63, v67
    v_mul_f32 v230, s36, v230
    v_mul_f32 v231, s36, v231
    v_cvt_pk_bf16_f32 v230, v230, v231
    v_accvgpr_write_b32 a35, v230
    v_mfma_f32_16x16x32_bf16 v[148:151], a[80:83], a[16:19], 0
    v_lshlrev_b32 v224, 16, v68
    v_and_b32 v225, s63, v68
    v_mul_f32 v224, s36, v224
    v_mul_f32 v225, s36, v225
    v_cvt_pk_bf16_f32 v224, v224, v225
    v_accvgpr_write_b32 a36, v224
    v_mfma_f32_16x16x32_bf16 v[148:151], a[84:87], a[20:23], v[148:151]
    v_lshlrev_b32 v226, 16, v69
    v_and_b32 v227, s63, v69
    v_mul_f32 v226, s36, v226
    v_mul_f32 v227, s36, v227
    v_cvt_pk_bf16_f32 v226, v226, v227
    v_accvgpr_write_b32 a37, v226
    v_mfma_f32_16x16x32_bf16 v[148:151], a[88:91], a[24:27], v[148:151]
    v_lshlrev_b32 v228, 16, v70
    v_and_b32 v229, s63, v70
    v_mul_f32 v228, s36, v228
    v_mul_f32 v229, s36, v229
    v_cvt_pk_bf16_f32 v228, v228, v229
    v_accvgpr_write_b32 a38, v228
    v_mfma_f32_16x16x32_bf16 v[148:151], a[92:95], a[28:31], v[148:151]
    v_lshlrev_b32 v230, 16, v71
    v_and_b32 v231, s63, v71
    v_mul_f32 v230, s36, v230
    v_mul_f32 v231, s36, v231
    v_cvt_pk_bf16_f32 v230, v230, v231
    v_accvgpr_write_b32 a39, v230
    v_mfma_f32_16x16x32_bf16 v[152:155], a[96:99], a[16:19], 0
    v_lshlrev_b32 v224, 16, v72
    v_and_b32 v225, s63, v72
    v_mul_f32 v224, s36, v224
    v_mul_f32 v225, s36, v225
    v_cvt_pk_bf16_f32 v224, v224, v225
    v_accvgpr_write_b32 a40, v224
    v_mfma_f32_16x16x32_bf16 v[152:155], a[100:103], a[20:23], v[152:155]
    v_lshlrev_b32 v226, 16, v73
    v_and_b32 v227, s63, v73
    v_mul_f32 v226, s36, v226
    v_mul_f32 v227, s36, v227
    v_cvt_pk_bf16_f32 v226, v226, v227
    v_accvgpr_write_b32 a41, v226
    v_mfma_f32_16x16x32_bf16 v[152:155], a[104:107], a[24:27], v[152:155]
    v_lshlrev_b32 v228, 16, v74
    v_and_b32 v229, s63, v74
    v_mul_f32 v228, s36, v228
    v_mul_f32 v229, s36, v229
    v_cvt_pk_bf16_f32 v228, v228, v229
    v_accvgpr_write_b32 a42, v228
    v_mfma_f32_16x16x32_bf16 v[152:155], a[108:111], a[28:31], v[152:155]
    v_lshlrev_b32 v230, 16, v75
    v_and_b32 v231, s63, v75
    v_mul_f32 v230, s36, v230
    v_mul_f32 v231, s36, v231
    v_cvt_pk_bf16_f32 v230, v230, v231
    v_accvgpr_write_b32 a43, v230
    v_mfma_f32_16x16x32_bf16 v[156:159], a[112:115], a[16:19], 0
    v_lshlrev_b32 v224, 16, v76
    v_and_b32 v225, s63, v76
    v_mul_f32 v224, s36, v224
    v_mul_f32 v225, s36, v225
    v_cvt_pk_bf16_f32 v224, v224, v225
    v_accvgpr_write_b32 a44, v224
    v_mfma_f32_16x16x32_bf16 v[156:159], a[116:119], a[20:23], v[156:159]
    v_lshlrev_b32 v226, 16, v77
    v_and_b32 v227, s63, v77
    v_mul_f32 v226, s36, v226
    v_mul_f32 v227, s36, v227
    v_cvt_pk_bf16_f32 v226, v226, v227
    v_accvgpr_write_b32 a45, v226
    v_mfma_f32_16x16x32_bf16 v[156:159], a[120:123], a[24:27], v[156:159]
    v_lshlrev_b32 v228, 16, v78
    v_and_b32 v229, s63, v78
    v_mul_f32 v228, s36, v228
    v_mul_f32 v229, s36, v229
    v_cvt_pk_bf16_f32 v228, v228, v229
    v_accvgpr_write_b32 a46, v228
    v_mfma_f32_16x16x32_bf16 v[156:159], a[124:127], a[28:31], v[156:159]
    v_lshlrev_b32 v230, 16, v79
    v_and_b32 v231, s63, v79
    v_mul_f32 v230, s36, v230
    v_mul_f32 v231, s36, v231
    v_cvt_pk_bf16_f32 v230, v230, v231
    v_accvgpr_write_b32 a47, v230
    v_smfmac_f32_16x16x64_bf16 v[176:179], v[204:207], v[128:135], v220
    v_mfma_f32_16x16x32_bf16 v[0:3], a[128:131], v[128:131], 0
    v_mfma_f32_16x16x32_bf16 v[0:3], a[132:135], v[132:135], v[0:3]
    v_mfma_f32_16x16x32_bf16 v[4:7], a[136:139], v[128:131], 0
    v_max3_f32 v241, v144, v145, v146
    v_max3_f32 v241, v241, v147, v148
    v_max3_f32 v241, v241, v149, v150
    v_max3_f32 v241, v241, v151, v152
    v_max3_f32 v241, v241, v153, v154
    v_mfma_f32_16x16x32_bf16 v[4:7], a[140:143], v[132:135], v[4:7]
    v_max3_f32 v241, v241, v155, v156
    v_max3_f32 v241, v241, v157, v158
    v_max_f32 v241, v241, v159
    v_mov_b32 v242, v241
    s_nop 1
    v_mfma_f32_16x16x32_bf16 v[8:11], a[144:147], v[128:131], 0
    v_permlane32_swap_b32 v241, v242
    v_max_f32 v241, v241, v242
    v_mov_b32 v242, v241
    s_nop 1
    v_permlane16_swap_b32 v241, v242
    v_mfma_f32_16x16x32_bf16 v[8:11], a[148:151], v[132:135], v[8:11]
    v_max_f32 v241, v241, v242
    v_sub_f32 v144, v144, v241
    v_sub_f32 v145, v145, v241
    v_sub_f32 v146, v146, v241
    v_sub_f32 v147, v147, v241
    v_mfma_f32_16x16x32_bf16 v[12:15], a[152:155], v[128:131], 0
    v_sub_f32 v148, v148, v241
    v_sub_f32 v149, v149, v241
    v_sub_f32 v150, v150, v241
    v_sub_f32 v151, v151, v241
    v_mfma_f32_16x16x32_bf16 v[12:15], a[156:159], v[132:135], v[12:15]
    v_sub_f32 v152, v152, v241
    v_sub_f32 v153, v153, v241
    v_sub_f32 v154, v154, v241
    v_sub_f32 v155, v155, v241
    v_mfma_f32_16x16x32_bf16 v[16:19], a[160:163], v[128:131], 0
    v_sub_f32 v156, v156, v241
    v_sub_f32 v157, v157, v241
    v_sub_f32 v158, v158, v241
    v_sub_f32 v159, v159, v241
    v_mfma_f32_16x16x32_bf16 v[16:19], a[164:167], v[132:135], v[16:19]
    v_exp_f32 v144, v144
    v_exp_f32 v145, v145
    v_exp_f32 v146, v146
    v_perm_b32 v144, v145, v144, s27
    v_mfma_f32_16x16x32_bf16 v[20:23], a[168:171], v[128:131], 0
    v_exp_f32 v147, v147
    v_exp_f32 v148, v148
    v_perm_b32 v145, v147, v146, s27
    v_exp_f32 v149, v149
    v_mfma_f32_16x16x32_bf16 v[20:23], a[172:175], v[132:135], v[20:23]
    v_exp_f32 v150, v150
    v_perm_b32 v146, v149, v148, s27
    v_exp_f32 v151, v151
    v_exp_f32 v152, v152
    v_mfma_f32_16x16x32_bf16 v[24:27], a[176:179], v[128:131], 0
    v_perm_b32 v147, v151, v150, s27
    v_exp_f32 v153, v153
    v_exp_f32 v154, v154
    v_perm_b32 v148, v153, v152, s27
    v_mfma_f32_16x16x32_bf16 v[24:27], a[180:183], v[132:135], v[24:27]
    v_exp_f32 v155, v155
    v_exp_f32 v156, v156
    v_perm_b32 v149, v155, v154, s27
    v_exp_f32 v157, v157
    v_mfma_f32_16x16x32_bf16 v[28:31], a[184:187], v[128:131], 0
    v_exp_f32 v158, v158
    v_perm_b32 v150, v157, v156, s27
    v_exp_f32 v159, v159
    v_sub_f32 v164, 0, v241
    v_mfma_f32_16x16x32_bf16 v[28:31], a[188:191], v[132:135], v[28:31]
    v_sub_f32 v165, 0, v241
    v_sub_f32 v166, 0, v241
    v_sub_f32 v167, 0, v241
    v_perm_b32 v151, v159, v158, s27
    s_waitcnt vmcnt(8)
    ds_read_b128 v[96:99], v248 offset:12288
    ds_read_b128 v[100:103], v249 offset:12288
    ds_read_b128 v[104:107], v250 offset:12288
    ds_read_b128 v[108:111], v251 offset:12288
    s_waitcnt lgkmcnt(0)
    v_mfma_f32_16x16x32_bf16 v[128:131], a[64:67], a[32:35], 0
    v_lshlrev_b32 v224, 16, v96
    v_and_b32 v225, s63, v96
    v_mul_f32 v224, s36, v224
    v_mul_f32 v225, s36, v225
    v_cvt_pk_bf16_f32 v224, v224, v225
    v_accvgpr_write_b32 a48, v224
    v_mfma_f32_16x16x32_bf16 v[128:131], a[68:71], a[36:39], v[128:131]
    v_lshlrev_b32 v226, 16, v97
    v_and_b32 v227, s63, v97
    v_mul_f32 v226, s36, v226
    v_mul_f32 v227, s36, v227
    v_cvt_pk_bf16_f32 v226, v226, v227
    v_accvgpr_write_b32 a49, v226
    v_mfma_f32_16x16x32_bf16 v[128:131], a[72:75], a[40:43], v[128:131]
    v_lshlrev_b32 v228, 16, v98
    v_and_b32 v229, s63, v98
    v_mul_f32 v228, s36, v228
    v_mul_f32 v229, s36, v229
    v_cvt_pk_bf16_f32 v228, v228, v229
    v_accvgpr_write_b32 a50, v228
    v_mfma_f32_16x16x32_bf16 v[128:131], a[76:79], a[44:47], v[128:131]
    v_lshlrev_b32 v230, 16, v99
    v_and_b32 v231, s63, v99
    v_mul_f32 v230, s36, v230
    v_mul_f32 v231, s36, v231
    v_cvt_pk_bf16_f32 v230, v230, v231
    v_accvgpr_write_b32 a51, v230
    v_mfma_f32_16x16x32_bf16 v[132:135], a[80:83], a[32:35], 0
    v_lshlrev_b32 v224, 16, v100
    v_and_b32 v225, s63, v100
    v_mul_f32 v224, s36, v224
    v_mul_f32 v225, s36, v225
    v_cvt_pk_bf16_f32 v224, v224, v225
    v_accvgpr_write_b32 a52, v224
    v_mfma_f32_16x16x32_bf16 v[132:135], a[84:87], a[36:39], v[132:135]
    v_lshlrev_b32 v226, 16, v101
    v_and_b32 v227, s63, v101
    v_mul_f32 v226, s36, v226
    v_mul_f32 v227, s36, v227
    v_cvt_pk_bf16_f32 v226, v226, v227
    v_accvgpr_write_b32 a53, v226
    v_mfma_f32_16x16x32_bf16 v[132:135], a[88:91], a[40:43], v[132:135]
    v_lshlrev_b32 v228, 16, v102
    v_and_b32 v229, s63, v102
    v_mul_f32 v228, s36, v228
    v_mul_f32 v229, s36, v229
    v_cvt_pk_bf16_f32 v228, v228, v229
    v_accvgpr_write_b32 a54, v228
    v_mfma_f32_16x16x32_bf16 v[132:135], a[92:95], a[44:47], v[132:135]
    v_lshlrev_b32 v230, 16, v103
    v_and_b32 v231, s63, v103
    v_mul_f32 v230, s36, v230
    v_mul_f32 v231, s36, v231
    v_cvt_pk_bf16_f32 v230, v230, v231
    v_accvgpr_write_b32 a55, v230
    v_mfma_f32_16x16x32_bf16 v[136:139], a[96:99], a[32:35], 0
    v_lshlrev_b32 v224, 16, v104
    v_and_b32 v225, s63, v104
    v_mul_f32 v224, s36, v224
    v_mul_f32 v225, s36, v225
    v_cvt_pk_bf16_f32 v224, v224, v225
    v_accvgpr_write_b32 a56, v224
    v_mfma_f32_16x16x32_bf16 v[136:139], a[100:103], a[36:39], v[136:139]
    v_lshlrev_b32 v226, 16, v105
    v_and_b32 v227, s63, v105
    v_mul_f32 v226, s36, v226
    v_mul_f32 v227, s36, v227
    v_cvt_pk_bf16_f32 v226, v226, v227
    v_accvgpr_write_b32 a57, v226
    v_mfma_f32_16x16x32_bf16 v[136:139], a[104:107], a[40:43], v[136:139]
    v_lshlrev_b32 v228, 16, v106
    v_and_b32 v229, s63, v106
    v_mul_f32 v228, s36, v228
    v_mul_f32 v229, s36, v229
    v_cvt_pk_bf16_f32 v228, v228, v229
    v_accvgpr_write_b32 a58, v228
    v_mfma_f32_16x16x32_bf16 v[136:139], a[108:111], a[44:47], v[136:139]
    v_lshlrev_b32 v230, 16, v107
    v_and_b32 v231, s63, v107
    v_mul_f32 v230, s36, v230
    v_mul_f32 v231, s36, v231
    v_cvt_pk_bf16_f32 v230, v230, v231
    v_accvgpr_write_b32 a59, v230
    v_mfma_f32_16x16x32_bf16 v[140:143], a[112:115], a[32:35], 0
    v_lshlrev_b32 v224, 16, v108
    v_and_b32 v225, s63, v108
    v_mul_f32 v224, s36, v224
    v_mul_f32 v225, s36, v225
    v_cvt_pk_bf16_f32 v224, v224, v225
    v_accvgpr_write_b32 a60, v224
    v_mfma_f32_16x16x32_bf16 v[140:143], a[116:119], a[36:39], v[140:143]
    v_lshlrev_b32 v226, 16, v109
    v_and_b32 v227, s63, v109
    v_mul_f32 v226, s36, v226
    v_mul_f32 v227, s36, v227
    v_cvt_pk_bf16_f32 v226, v226, v227
    v_accvgpr_write_b32 a61, v226
    v_mfma_f32_16x16x32_bf16 v[140:143], a[120:123], a[40:43], v[140:143]
    v_lshlrev_b32 v228, 16, v110
    v_and_b32 v229, s63, v110
    v_mul_f32 v228, s36, v228
    v_mul_f32 v229, s36, v229
    v_cvt_pk_bf16_f32 v228, v228, v229
    v_accvgpr_write_b32 a62, v228
    v_mfma_f32_16x16x32_bf16 v[140:143], a[124:127], a[44:47], v[140:143]
    v_lshlrev_b32 v230, 16, v111
    v_and_b32 v231, s63, v111
    v_mul_f32 v230, s36, v230
    v_mul_f32 v231, s36, v231
    v_cvt_pk_bf16_f32 v230, v230, v231
    v_accvgpr_write_b32 a63, v230
    v_smfmac_f32_16x16x64_bf16 v[180:183], v[204:207], v[144:151], v220
    v_mfma_f32_16x16x32_bf16 v[32:35], a[128:131], v[144:147], 0
    v_mfma_f32_16x16x32_bf16 v[32:35], a[132:135], v[148:151], v[32:35]
    v_mfma_f32_16x16x32_bf16 v[36:39], a[136:139], v[144:147], 0
    v_max3_f32 v241, v128, v129, v130
    v_max3_f32 v241, v241, v131, v132
    v_max3_f32 v241, v241, v133, v134
    v_max3_f32 v241, v241, v135, v136
    v_max3_f32 v241, v241, v137, v138
    v_mfma_f32_16x16x32_bf16 v[36:39], a[140:143], v[148:151], v[36:39]
    v_max3_f32 v241, v241, v139, v140
    v_max3_f32 v241, v241, v141, v142
    v_max_f32 v241, v241, v143
    v_mov_b32 v242, v241
    s_nop 1
    v_mfma_f32_16x16x32_bf16 v[40:43], a[144:147], v[144:147], 0
    v_permlane32_swap_b32 v241, v242
    v_max_f32 v241, v241, v242
    v_mov_b32 v242, v241
    s_nop 1
    v_permlane16_swap_b32 v241, v242
    v_mfma_f32_16x16x32_bf16 v[40:43], a[148:151], v[148:151], v[40:43]
    v_max_f32 v241, v241, v242
    v_sub_f32 v128, v128, v241
    v_sub_f32 v129, v129, v241
    v_sub_f32 v130, v130, v241
    v_sub_f32 v131, v131, v241
    v_mfma_f32_16x16x32_bf16 v[44:47], a[152:155], v[144:147], 0
    v_sub_f32 v132, v132, v241
    v_sub_f32 v133, v133, v241
    v_sub_f32 v134, v134, v241
    v_sub_f32 v135, v135, v241
    v_mfma_f32_16x16x32_bf16 v[44:47], a[156:159], v[148:151], v[44:47]
    v_sub_f32 v136, v136, v241
    v_sub_f32 v137, v137, v241
    v_sub_f32 v138, v138, v241
    v_sub_f32 v139, v139, v241
    v_mfma_f32_16x16x32_bf16 v[48:51], a[160:163], v[144:147], 0
    v_sub_f32 v140, v140, v241
    v_sub_f32 v141, v141, v241
    v_sub_f32 v142, v142, v241
    v_sub_f32 v143, v143, v241
    v_mfma_f32_16x16x32_bf16 v[48:51], a[164:167], v[148:151], v[48:51]
    v_exp_f32 v128, v128
    v_exp_f32 v129, v129
    v_exp_f32 v130, v130
    v_perm_b32 v128, v129, v128, s27
    v_mfma_f32_16x16x32_bf16 v[52:55], a[168:171], v[144:147], 0
    v_exp_f32 v131, v131
    v_exp_f32 v132, v132
    v_perm_b32 v129, v131, v130, s27
    v_exp_f32 v133, v133
    v_mfma_f32_16x16x32_bf16 v[52:55], a[172:175], v[148:151], v[52:55]
    v_exp_f32 v134, v134
    v_perm_b32 v130, v133, v132, s27
    v_exp_f32 v135, v135
    v_exp_f32 v136, v136
    v_mfma_f32_16x16x32_bf16 v[56:59], a[176:179], v[144:147], 0
    v_perm_b32 v131, v135, v134, s27
    v_exp_f32 v137, v137
    v_exp_f32 v138, v138
    v_perm_b32 v132, v137, v136, s27
    v_mfma_f32_16x16x32_bf16 v[56:59], a[180:183], v[148:151], v[56:59]
    v_exp_f32 v139, v139
    v_exp_f32 v140, v140
    v_perm_b32 v133, v139, v138, s27
    v_exp_f32 v141, v141
    v_mfma_f32_16x16x32_bf16 v[60:63], a[184:187], v[144:147], 0
    v_exp_f32 v142, v142
    v_perm_b32 v134, v141, v140, s27
    v_exp_f32 v143, v143
    v_sub_f32 v168, 0, v241
    v_mfma_f32_16x16x32_bf16 v[60:63], a[188:191], v[148:151], v[60:63]
    v_sub_f32 v169, 0, v241
    v_sub_f32 v170, 0, v241
    v_sub_f32 v171, 0, v241
    v_perm_b32 v135, v143, v142, s27
    s_nop 0
    v_mfma_f32_16x16x32_bf16 v[144:147], a[64:67], a[48:51], 0
    v_mfma_f32_16x16x32_bf16 v[144:147], a[68:71], a[52:55], v[144:147]
    v_mfma_f32_16x16x32_bf16 v[144:147], a[72:75], a[56:59], v[144:147]
    v_mfma_f32_16x16x32_bf16 v[144:147], a[76:79], a[60:63], v[144:147]
    v_mfma_f32_16x16x32_bf16 v[148:151], a[80:83], a[48:51], 0
    v_mfma_f32_16x16x32_bf16 v[148:151], a[84:87], a[52:55], v[148:151]
    v_mfma_f32_16x16x32_bf16 v[148:151], a[88:91], a[56:59], v[148:151]
    v_mfma_f32_16x16x32_bf16 v[148:151], a[92:95], a[60:63], v[148:151]
    v_mfma_f32_16x16x32_bf16 v[152:155], a[96:99], a[48:51], 0
    v_mfma_f32_16x16x32_bf16 v[152:155], a[100:103], a[52:55], v[152:155]
    v_mfma_f32_16x16x32_bf16 v[152:155], a[104:107], a[56:59], v[152:155]
    v_mfma_f32_16x16x32_bf16 v[152:155], a[108:111], a[60:63], v[152:155]
    v_mfma_f32_16x16x32_bf16 v[156:159], a[112:115], a[48:51], 0
    v_mfma_f32_16x16x32_bf16 v[156:159], a[116:119], a[52:55], v[156:159]
    v_mfma_f32_16x16x32_bf16 v[156:159], a[120:123], a[56:59], v[156:159]
    v_mfma_f32_16x16x32_bf16 v[156:159], a[124:127], a[60:63], v[156:159]
    s_waitcnt vmcnt(4)
    s_barrier
    ds_read_b128 a[64:67], v192 offset:32768
    ds_read_b128 a[68:71], v193 offset:32768
    ds_read_b128 a[72:75], v194 offset:32768
    ds_read_b128 a[76:79], v195 offset:32768
    ds_read_b128 a[80:83], v192 offset:36864
    ds_read_b128 a[84:87], v193 offset:36864
    ds_read_b128 a[88:91], v194 offset:36864
    ds_read_b128 a[92:95], v195 offset:36864
    ds_read_b128 a[96:99], v192 offset:40960
    ds_read_b128 a[100:103], v193 offset:40960
    ds_read_b128 a[104:107], v194 offset:40960
    ds_read_b128 a[108:111], v195 offset:40960
    ds_read_b128 a[112:115], v192 offset:45056
    ds_read_b128 a[116:119], v193 offset:45056
    ds_read_b128 a[120:123], v194 offset:45056
    ds_read_b128 a[124:127], v195 offset:45056
    v_smfmac_f32_16x16x64_bf16 v[184:187], v[204:207], v[128:135], v220
    v_mfma_f32_16x16x32_bf16 v[64:67], a[128:131], v[128:131], 0
    v_mfma_f32_16x16x32_bf16 v[64:67], a[132:135], v[132:135], v[64:67]
    v_mfma_f32_16x16x32_bf16 v[68:71], a[136:139], v[128:131], 0
    v_max3_f32 v241, v144, v145, v146
    v_max3_f32 v241, v241, v147, v148
    v_max3_f32 v241, v241, v149, v150
    v_max3_f32 v241, v241, v151, v152
    v_max3_f32 v241, v241, v153, v154
    v_mfma_f32_16x16x32_bf16 v[68:71], a[140:143], v[132:135], v[68:71]
    v_max3_f32 v241, v241, v155, v156
    v_max3_f32 v241, v241, v157, v158
    v_max_f32 v241, v241, v159
    v_mov_b32 v242, v241
    s_nop 1
    v_mfma_f32_16x16x32_bf16 v[72:75], a[144:147], v[128:131], 0
    v_permlane32_swap_b32 v241, v242
    v_max_f32 v241, v241, v242
    v_mov_b32 v242, v241
    s_nop 1
    v_permlane16_swap_b32 v241, v242
    v_mfma_f32_16x16x32_bf16 v[72:75], a[148:151], v[132:135], v[72:75]
    v_max_f32 v241, v241, v242
    v_sub_f32 v144, v144, v241
    v_sub_f32 v145, v145, v241
    v_sub_f32 v146, v146, v241
    v_sub_f32 v147, v147, v241
    v_mfma_f32_16x16x32_bf16 v[76:79], a[152:155], v[128:131], 0
    v_sub_f32 v148, v148, v241
    v_sub_f32 v149, v149, v241
    v_sub_f32 v150, v150, v241
    v_sub_f32 v151, v151, v241
    v_mfma_f32_16x16x32_bf16 v[76:79], a[156:159], v[132:135], v[76:79]
    v_sub_f32 v152, v152, v241
    v_sub_f32 v153, v153, v241
    v_sub_f32 v154, v154, v241
    v_sub_f32 v155, v155, v241
    v_mfma_f32_16x16x32_bf16 v[80:83], a[160:163], v[128:131], 0
    v_sub_f32 v156, v156, v241
    v_sub_f32 v157, v157, v241
    v_sub_f32 v158, v158, v241
    v_sub_f32 v159, v159, v241
    v_mfma_f32_16x16x32_bf16 v[80:83], a[164:167], v[132:135], v[80:83]
    v_exp_f32 v144, v144
    v_exp_f32 v145, v145
    v_exp_f32 v146, v146
    v_perm_b32 v144, v145, v144, s27
    v_mfma_f32_16x16x32_bf16 v[84:87], a[168:171], v[128:131], 0
    v_exp_f32 v147, v147
    v_exp_f32 v148, v148
    v_perm_b32 v145, v147, v146, s27
    v_exp_f32 v149, v149
    v_mfma_f32_16x16x32_bf16 v[84:87], a[172:175], v[132:135], v[84:87]
    v_exp_f32 v150, v150
    v_perm_b32 v146, v149, v148, s27
    v_exp_f32 v151, v151
    v_exp_f32 v152, v152
    v_mfma_f32_16x16x32_bf16 v[88:91], a[176:179], v[128:131], 0
    v_perm_b32 v147, v151, v150, s27
    v_exp_f32 v153, v153
    v_exp_f32 v154, v154
    v_perm_b32 v148, v153, v152, s27
    v_mfma_f32_16x16x32_bf16 v[88:91], a[180:183], v[132:135], v[88:91]
    v_exp_f32 v155, v155
    v_exp_f32 v156, v156
    v_perm_b32 v149, v155, v154, s27
    v_exp_f32 v157, v157
    v_mfma_f32_16x16x32_bf16 v[92:95], a[184:187], v[128:131], 0
    v_exp_f32 v158, v158
    v_perm_b32 v150, v157, v156, s27
    v_exp_f32 v159, v159
    v_sub_f32 v172, 0, v241
    v_mfma_f32_16x16x32_bf16 v[92:95], a[188:191], v[132:135], v[92:95]
    v_sub_f32 v173, 0, v241
    v_sub_f32 v174, 0, v241
    v_sub_f32 v175, 0, v241
    v_perm_b32 v151, v159, v158, s27
    s_waitcnt lgkmcnt(0)
    v_mfma_f32_16x16x32_bf16 v[128:131], a[64:67], a[0:3], v[160:163]
    v_mfma_f32_16x16x32_bf16 v[128:131], a[68:71], a[4:7], v[128:131]
    v_mfma_f32_16x16x32_bf16 v[128:131], a[72:75], a[8:11], v[128:131]
    v_mfma_f32_16x16x32_bf16 v[128:131], a[76:79], a[12:15], v[128:131]
    v_mfma_f32_16x16x32_bf16 v[132:135], a[80:83], a[0:3], v[160:163]
    v_mfma_f32_16x16x32_bf16 v[132:135], a[84:87], a[4:7], v[132:135]
    s_nop 0
    v_mfma_f32_16x16x32_bf16 v[132:135], a[88:91], a[8:11], v[132:135]
    v_mfma_f32_16x16x32_bf16 v[132:135], a[92:95], a[12:15], v[132:135]
    v_mfma_f32_16x16x32_bf16 v[136:139], a[96:99], a[0:3], v[160:163]
    v_mfma_f32_16x16x32_bf16 v[136:139], a[100:103], a[4:7], v[136:139]
    v_mfma_f32_16x16x32_bf16 v[136:139], a[104:107], a[8:11], v[136:139]
    v_exp_f32 v128, v128
    v_mfma_f32_16x16x32_bf16 v[136:139], a[108:111], a[12:15], v[136:139]
    v_mfma_f32_16x16x32_bf16 v[140:143], a[112:115], a[0:3], v[160:163]
    v_exp_f32 v129, v129
    v_mfma_f32_16x16x32_bf16 v[140:143], a[116:119], a[4:7], v[140:143]
    v_perm_b32 v128, v129, v128, s27
    v_mfma_f32_16x16x32_bf16 v[140:143], a[120:123], a[8:11], v[140:143]
    v_exp_f32 v130, v130
    v_mfma_f32_16x16x32_bf16 v[140:143], a[124:127], a[12:15], v[140:143]
    v_smfmac_f32_16x16x64_bf16 v[188:191], v[204:207], v[144:151], v220
    v_exp_f32 v131, v131
    v_mfma_f32_16x16x32_bf16 v[96:99], a[128:131], v[144:147], 0
    v_perm_b32 v129, v131, v130, s27
    v_mfma_f32_16x16x32_bf16 v[96:99], a[132:135], v[148:151], v[96:99]
    v_exp_f32 v132, v132
    v_mfma_f32_16x16x32_bf16 v[100:103], a[136:139], v[144:147], 0
    v_mfma_f32_16x16x32_bf16 v[100:103], a[140:143], v[148:151], v[100:103]
    v_exp_f32 v133, v133
    v_mfma_f32_16x16x32_bf16 v[104:107], a[144:147], v[144:147], 0
    v_perm_b32 v130, v133, v132, s27
    v_mfma_f32_16x16x32_bf16 v[104:107], a[148:151], v[148:151], v[104:107]
    v_exp_f32 v134, v134
    v_mfma_f32_16x16x32_bf16 v[108:111], a[152:155], v[144:147], 0
    v_mfma_f32_16x16x32_bf16 v[108:111], a[156:159], v[148:151], v[108:111]
    v_exp_f32 v135, v135
    v_mfma_f32_16x16x32_bf16 v[112:115], a[160:163], v[144:147], 0
    v_perm_b32 v131, v135, v134, s27
    v_mfma_f32_16x16x32_bf16 v[112:115], a[164:167], v[148:151], v[112:115]
    v_exp_f32 v136, v136
    v_mfma_f32_16x16x32_bf16 v[116:119], a[168:171], v[144:147], 0
    v_mfma_f32_16x16x32_bf16 v[116:119], a[172:175], v[148:151], v[116:119]
    v_exp_f32 v137, v137
    v_mfma_f32_16x16x32_bf16 v[120:123], a[176:179], v[144:147], 0
    v_perm_b32 v132, v137, v136, s27
    v_mfma_f32_16x16x32_bf16 v[120:123], a[180:183], v[148:151], v[120:123]
    v_exp_f32 v138, v138
    v_mfma_f32_16x16x32_bf16 v[124:127], a[184:187], v[144:147], 0
    v_mfma_f32_16x16x32_bf16 v[124:127], a[188:191], v[148:151], v[124:127]
    v_exp_f32 v139, v139
    s_waitcnt vmcnt(0)
    s_barrier
    ds_read_b64_tr_b16 a[192:193], v196 offset:49152
    ds_read_b64_tr_b16 a[194:195], v196 offset:53248
    ds_read_b64_tr_b16 a[196:197], v196 offset:57344
    ds_read_b64_tr_b16 a[198:199], v196 offset:61440
    ds_read_b64_tr_b16 a[200:201], v197 offset:49152
    ds_read_b64_tr_b16 a[202:203], v197 offset:53248
    ds_read_b64_tr_b16 a[204:205], v197 offset:57344
    ds_read_b64_tr_b16 a[206:207], v197 offset:61440
    ds_read_b64_tr_b16 a[208:209], v198 offset:49152
    ds_read_b64_tr_b16 a[210:211], v198 offset:53248
    ds_read_b64_tr_b16 a[212:213], v198 offset:57344
    ds_read_b64_tr_b16 a[214:215], v198 offset:61440
    ds_read_b64_tr_b16 a[216:217], v199 offset:49152
    ds_read_b64_tr_b16 a[218:219], v199 offset:53248
    ds_read_b64_tr_b16 a[220:221], v199 offset:57344
    ds_read_b64_tr_b16 a[222:223], v199 offset:61440
    ds_read_b64_tr_b16 a[224:225], v200 offset:49152
    ds_read_b64_tr_b16 a[226:227], v200 offset:53248
    ds_read_b64_tr_b16 a[228:229], v200 offset:57344
    ds_read_b64_tr_b16 a[230:231], v200 offset:61440
    ds_read_b64_tr_b16 a[232:233], v201 offset:49152
    ds_read_b64_tr_b16 a[234:235], v201 offset:53248
    ds_read_b64_tr_b16 a[236:237], v201 offset:57344
    ds_read_b64_tr_b16 a[238:239], v201 offset:61440
    ds_read_b64_tr_b16 a[240:241], v202 offset:49152
    ds_read_b64_tr_b16 a[242:243], v202 offset:53248
    s_add_u32 s26, s26, 1
    s_branch L_entryA
L_proB:
    v_add_u32 v96, 4096, v208
    v_add_u32 v97, 4096, v209
    v_add_u32 v98, 4096, v210
    v_add_u32 v99, 4096, v211
    v_add_u32 v108, 4096, v212
    v_add_u32 v109, 4096, v213
    v_add_u32 v100, 8192, v208
    v_add_u32 v101, 8192, v209
    v_add_u32 v102, 8192, v210
    v_add_u32 v103, 8192, v211
    v_add_u32 v110, 8192, v212
    v_add_u32 v111, 8192, v213
    v_add_u32 v104, 12288, v208
    v_add_u32 v105, 12288, v209
    v_add_u32 v106, 12288, v210
    v_add_u32 v107, 12288, v211
    v_add_u32 v112, 12288, v212
    v_add_u32 v113, 12288, v213
    v_xor_b32 v226, v224, v225
    v_lshlrev_b32 v226, 4, v226
    v_lshl_add_u32 v192, v224, 8, v226
    v_xor_b32 v193, 64, v192
    v_xor_b32 v194, 128, v192
    v_xor_b32 v195, 192, v192
    v_add_u32 v248, s42, v192
    v_add_u32 v249, s42, v193
    v_add_u32 v250, s42, v194
    v_add_u32 v251, s42, v195
    v_lshrrev_b32 v226, 2, v214
    v_and_b32 v227, 7, v226
    v_lshlrev_b32 v226, 8, v226
    v_lshl_add_u32 v226, v227, 5, v226
    v_and_b32 v227, 3, v214
    v_lshl_add_u32 v196, v227, 3, v226
    v_xor_b32 v197, 32, v196
    v_xor_b32 v198, 64, v196
    v_xor_b32 v199, 96, v196
    v_xor_b32 v200, 128, v196
    v_xor_b32 v201, 160, v196
    v_xor_b32 v202, 192, v196
    v_xor_b32 v203, 224, v196
    v_cmp_eq_u32 vcc, 0, v227
    v_mov_b32 v226, 0xeeeeeeee
    v_mov_b32 v228, 0x44444444
    v_cndmask_b32 v220, v226, v228, vcc
    v_cmp_gt_u32 vcc, 2, v227
    v_mov_b32 v226, 0x3f803f80
    s_mov_b32 s36, 0x3e0293ee
    s_mov_b32 s37, 0x3e0293ee
    v_cndmask_b32 v204, 0, v226, vcc
    v_cndmask_b32 v205, 0, v226, vcc
    v_cndmask_b32 v206, 0, v226, vcc
    v_cndmask_b32 v207, 0, v226, vcc
    s_lshl_b32 s38, s20, 13
    s_add_u32 s38, s38, 131072
    v_and_b32 v244, 15, v214
    v_lshrrev_b32 v245, 4, v214
    v_lshrrev_b32 v246, 1, v245
    v_and_b32 v247, 7, v244
    v_xor_b32 v246, v246, v247
    v_lshlrev_b32 v246, 4, v246
    v_lshl_add_u32 v246, v244, 8, v246
    v_and_b32 v247, 1, v245
    v_lshl_add_u32 v246, v247, 3, v246
    v_add_u32 v232, s38, v246
    v_xor_b32 v233, 32, v232
    v_xor_b32 v234, 64, v232
    v_xor_b32 v235, 96, v232
    v_xor_b32 v236, 128, v232
    v_xor_b32 v237, 160, v232
    v_xor_b32 v238, 192, v232
    v_xor_b32 v239, 224, v232
    v_xor_b32 v246, v244, v245
    v_lshlrev_b32 v246, 4, v246
    v_lshl_add_u32 v246, v245, 8, v246
    v_add_u32 v216, s38, v246
    v_xor_b32 v240, 64, v216
    v_lshlrev_b32 v217, 4, v214
    v_mov_b32 v176, 0
    v_mov_b32 v177, 0
    v_mov_b32 v178, 0
    v_mov_b32 v179, 0
    v_mov_b32 v180, 0
    v_mov_b32 v181, 0
    v_mov_b32 v182, 0
    v_mov_b32 v183, 0
    v_mov_b32 v184, 0
    v_mov_b32 v185, 0
    v_mov_b32 v186, 0
    v_mov_b32 v187, 0
    s_mov_b32 s26, 0
    s_mov_b32 s63, 0xffff0000
    s_mov_b32 s27, 0x07060302
    s_waitcnt vmcnt(8)
    s_add_u32 m0, s21, 16384
    s_add_u32 s38, s21, 0
    buffer_load_dwordx4 v212, s[8:11], s38 offen offset:0 sc0 sc1 nt lds
    buffer_load_dwordx4 v213, s[8:11], s38 offen offset:1024 sc0 sc1 nt lds
    buffer_load_dwordx4 v212, s[8:11], s38 offen offset:2048 sc0 sc1 nt lds
    buffer_load_dwordx4 v213, s[8:11], s38 offen offset:3072 sc0 sc1 nt lds
    ds_read_b128 v[0:3], v248 offset:0
    ds_read_b128 v[4:7], v249 offset:0
    ds_read_b128 v[8:11], v250 offset:0
    ds_read_b128 v[12:15], v251 offset:0
    s_waitcnt lgkmcnt(3)
    v_lshlrev_b32 v224, 16, v0
    v_and_b32 v225, s63, v0
    v_pk_mul_f32 v[224:225], v[224:225], s[36:37]
    v_cvt_pk_bf16_f32 v224, v224, v225
    v_accvgpr_write_b32 a0, v224
    v_lshlrev_b32 v226, 16, v1
    v_and_b32 v227, s63, v1
    v_pk_mul_f32 v[226:227], v[226:227], s[36:37]
    v_cvt_pk_bf16_f32 v226, v226, v227
    v_accvgpr_write_b32 a1, v226
    v_lshlrev_b32 v228, 16, v2
    v_and_b32 v229, s63, v2
    v_pk_mul_f32 v[228:229], v[228:229], s[36:37]
    v_cvt_pk_bf16_f32 v228, v228, v229
    v_accvgpr_write_b32 a2, v228
    v_lshlrev_b32 v230, 16, v3
    v_and_b32 v231, s63, v3
    v_pk_mul_f32 v[230:231], v[230:231], s[36:37]
    v_cvt_pk_bf16_f32 v230, v230, v231
    v_accvgpr_write_b32 a3, v230
    s_waitcnt lgkmcnt(2)
    v_lshlrev_b32 v224, 16, v4
    v_and_b32 v225, s63, v4
    v_pk_mul_f32 v[224:225], v[224:225], s[36:37]
    v_cvt_pk_bf16_f32 v224, v224, v225
    v_accvgpr_write_b32 a4, v224
    v_lshlrev_b32 v226, 16, v5
    v_and_b32 v227, s63, v5
    v_pk_mul_f32 v[226:227], v[226:227], s[36:37]
    v_cvt_pk_bf16_f32 v226, v226, v227
    v_accvgpr_write_b32 a5, v226
    v_lshlrev_b32 v228, 16, v6
    v_and_b32 v229, s63, v6
    v_pk_mul_f32 v[228:229], v[228:229], s[36:37]
    v_cvt_pk_bf16_f32 v228, v228, v229
    v_accvgpr_write_b32 a6, v228
    v_lshlrev_b32 v230, 16, v7
    v_and_b32 v231, s63, v7
    v_pk_mul_f32 v[230:231], v[230:231], s[36:37]
    v_cvt_pk_bf16_f32 v230, v230, v231
    v_accvgpr_write_b32 a7, v230
    s_waitcnt lgkmcnt(1)
    v_lshlrev_b32 v224, 16, v8
    v_and_b32 v225, s63, v8
    v_pk_mul_f32 v[224:225], v[224:225], s[36:37]
    v_cvt_pk_bf16_f32 v224, v224, v225
    v_accvgpr_write_b32 a8, v224
    v_lshlrev_b32 v226, 16, v9
    v_and_b32 v227, s63, v9
    v_pk_mul_f32 v[226:227], v[226:227], s[36:37]
    v_cvt_pk_bf16_f32 v226, v226, v227
    v_accvgpr_write_b32 a9, v226
    v_lshlrev_b32 v228, 16, v10
    v_and_b32 v229, s63, v10
    v_pk_mul_f32 v[228:229], v[228:229], s[36:37]
    v_cvt_pk_bf16_f32 v228, v228, v229
    v_accvgpr_write_b32 a10, v228
    v_lshlrev_b32 v230, 16, v11
    v_and_b32 v231, s63, v11
    v_pk_mul_f32 v[230:231], v[230:231], s[36:37]
    v_cvt_pk_bf16_f32 v230, v230, v231
    v_accvgpr_write_b32 a11, v230
    s_waitcnt lgkmcnt(0)
    v_lshlrev_b32 v224, 16, v12
    v_and_b32 v225, s63, v12
    v_pk_mul_f32 v[224:225], v[224:225], s[36:37]
    v_cvt_pk_bf16_f32 v224, v224, v225
    v_accvgpr_write_b32 a12, v224
    v_lshlrev_b32 v226, 16, v13
    v_and_b32 v227, s63, v13
    v_pk_mul_f32 v[226:227], v[226:227], s[36:37]
    v_cvt_pk_bf16_f32 v226, v226, v227
    v_accvgpr_write_b32 a13, v226
    v_lshlrev_b32 v228, 16, v14
    v_and_b32 v229, s63, v14
    v_pk_mul_f32 v[228:229], v[228:229], s[36:37]
    v_cvt_pk_bf16_f32 v228, v228, v229
    v_accvgpr_write_b32 a14, v228
    v_lshlrev_b32 v230, 16, v15
    v_and_b32 v231, s63, v15
    v_pk_mul_f32 v[230:231], v[230:231], s[36:37]
    v_cvt_pk_bf16_f32 v230, v230, v231
    v_accvgpr_write_b32 a15, v230
    s_waitcnt vmcnt(8)
    s_barrier
    ds_read_b128 a[64:67], v192 offset:0
    ds_read_b128 a[68:71], v193 offset:0
    ds_read_b128 a[72:75], v194 offset:0
    ds_read_b128 a[76:79], v195 offset:0
    ds_read_b128 a[80:83], v192 offset:4096
    ds_read_b128 a[84:87], v193 offset:4096
    ds_read_b128 a[88:91], v194 offset:4096
    ds_read_b128 a[92:95], v195 offset:4096
    ds_read_b128 a[96:99], v192 offset:8192
    ds_read_b128 a[100:103], v193 offset:8192
    ds_read_b128 a[104:107], v194 offset:8192
    ds_read_b128 a[108:111], v195 offset:8192
    ds_read_b128 a[112:115], v192 offset:12288
    ds_read_b128 a[116:119], v193 offset:12288
    ds_read_b128 a[120:123], v194 offset:12288
    ds_read_b128 a[124:127], v195 offset:12288
    s_add_u32 m0, s42, 8192
    s_add_u32 s38, s43, 8192
    buffer_load_dwordx4 v208, s[12:15], s38 offen offset:0 sc0 sc1 nt lds
    buffer_load_dwordx4 v209, s[12:15], s38 offen offset:1024 sc0 sc1 nt lds
    buffer_load_dwordx4 v210, s[12:15], s38 offen offset:2048 sc0 sc1 nt lds
    buffer_load_dwordx4 v211, s[12:15], s38 offen offset:3072 sc0 sc1 nt lds
    s_waitcnt vmcnt(8)
    ds_read_b128 v[32:35], v248 offset:4096
    ds_read_b128 v[36:39], v249 offset:4096
    ds_read_b128 v[40:43], v250 offset:4096
    ds_read_b128 v[44:47], v251 offset:4096
    s_waitcnt lgkmcnt(0)
    v_mfma_f32_16x16x32_bf16 v[144:147], a[64:67], a[0:3], 0
    v_lshlrev_b32 v224, 16, v32
    v_and_b32 v225, s63, v32
    v_mul_f32 v224, s36, v224
    v_mul_f32 v225, s36, v225
    v_cvt_pk_bf16_f32 v224, v224, v225
    v_accvgpr_write_b32 a16, v224
    v_mfma_f32_16x16x32_bf16 v[144:147], a[68:71], a[4:7], v[144:147]
    v_lshlrev_b32 v226, 16, v33
    v_and_b32 v227, s63, v33
    v_mul_f32 v226, s36, v226
    v_mul_f32 v227, s36, v227
    v_cvt_pk_bf16_f32 v226, v226, v227
    v_accvgpr_write_b32 a17, v226
    v_mfma_f32_16x16x32_bf16 v[144:147], a[72:75], a[8:11], v[144:147]
    v_lshlrev_b32 v228, 16, v34
    v_and_b32 v229, s63, v34
    v_mul_f32 v228, s36, v228
    v_mul_f32 v229, s36, v229
    v_cvt_pk_bf16_f32 v228, v228, v229
    v_accvgpr_write_b32 a18, v228
    v_mfma_f32_16x16x32_bf16 v[144:147], a[76:79], a[12:15], v[144:147]
    v_lshlrev_b32 v230, 16, v35
    v_and_b32 v231, s63, v35
    v_mul_f32 v230, s36, v230
    v_mul_f32 v231, s36, v231
    v_cvt_pk_bf16_f32 v230, v230, v231
    v_accvgpr_write_b32 a19, v230
    v_mfma_f32_16x16x32_bf16 v[148:151], a[80:83], a[0:3], 0
    v_lshlrev_b32 v224, 16, v36
    v_and_b32 v225, s63, v36
    v_mul_f32 v224, s36, v224
    v_mul_f32 v225, s36, v225
    v_cvt_pk_bf16_f32 v224, v224, v225
    v_accvgpr_write_b32 a20, v224
    v_mfma_f32_16x16x32_bf16 v[148:151], a[84:87], a[4:7], v[148:151]
    v_lshlrev_b32 v226, 16, v37
    v_and_b32 v227, s63, v37
    v_mul_f32 v226, s36, v226
    v_mul_f32 v227, s36, v227
    v_cvt_pk_bf16_f32 v226, v226, v227
    v_accvgpr_write_b32 a21, v226
    v_mfma_f32_16x16x32_bf16 v[148:151], a[88:91], a[8:11], v[148:151]
    v_lshlrev_b32 v228, 16, v38
    v_and_b32 v229, s63, v38
    v_mul_f32 v228, s36, v228
    v_mul_f32 v229, s36, v229
    v_cvt_pk_bf16_f32 v228, v228, v229
    v_accvgpr_write_b32 a22, v228
    v_mfma_f32_16x16x32_bf16 v[148:151], a[92:95], a[12:15], v[148:151]
    v_lshlrev_b32 v230, 16, v39
    v_and_b32 v231, s63, v39
    v_mul_f32 v230, s36, v230
    v_mul_f32 v231, s36, v231
    v_cvt_pk_bf16_f32 v230, v230, v231
    v_accvgpr_write_b32 a23, v230
    v_mfma_f32_16x16x32_bf16 v[152:155], a[96:99], a[0:3], 0
    v_lshlrev_b32 v224, 16, v40
    v_and_b32 v225, s63, v40
    v_mul_f32 v224, s36, v224
    v_mul_f32 v225, s36, v225
    v_cvt_pk_bf16_f32 v224, v224, v225
    v_accvgpr_write_b32 a24, v224
    v_mfma_f32_16x16x32_bf16 v[152:155], a[100:103], a[4:7], v[152:155]
    v_lshlrev_b32 v226, 16, v41
    v_and_b32 v227, s63, v41
    v_mul_f32 v226, s36, v226
    v_mul_f32 v227, s36, v227
    v_cvt_pk_bf16_f32 v226, v226, v227
    v_accvgpr_write_b32 a25, v226
    v_mfma_f32_16x16x32_bf16 v[152:155], a[104:107], a[8:11], v[152:155]
    v_lshlrev_b32 v228, 16, v42
    v_and_b32 v229, s63, v42
    v_mul_f32 v228, s36, v228
    v_mul_f32 v229, s36, v229
    v_cvt_pk_bf16_f32 v228, v228, v229
    v_accvgpr_write_b32 a26, v228
    v_mfma_f32_16x16x32_bf16 v[152:155], a[108:111], a[12:15], v[152:155]
    v_lshlrev_b32 v230, 16, v43
    v_and_b32 v231, s63, v43
    v_mul_f32 v230, s36, v230
    v_mul_f32 v231, s36, v231
    v_cvt_pk_bf16_f32 v230, v230, v231
    v_accvgpr_write_b32 a27, v230
    v_mfma_f32_16x16x32_bf16 v[156:159], a[112:115], a[0:3], 0
    v_lshlrev_b32 v224, 16, v44
    v_and_b32 v225, s63, v44
    v_mul_f32 v224, s36, v224
    v_mul_f32 v225, s36, v225
    v_cvt_pk_bf16_f32 v224, v224, v225
    v_accvgpr_write_b32 a28, v224
    v_mfma_f32_16x16x32_bf16 v[156:159], a[116:119], a[4:7], v[156:159]
    v_lshlrev_b32 v226, 16, v45
    v_and_b32 v227, s63, v45
    v_mul_f32 v226, s36, v226
    v_mul_f32 v227, s36, v227
    v_cvt_pk_bf16_f32 v226, v226, v227
    v_accvgpr_write_b32 a29, v226
    v_mfma_f32_16x16x32_bf16 v[156:159], a[120:123], a[8:11], v[156:159]
    v_lshlrev_b32 v228, 16, v46
    v_and_b32 v229, s63, v46
    v_mul_f32 v228, s36, v228
    v_mul_f32 v229, s36, v229
    v_cvt_pk_bf16_f32 v228, v228, v229
    v_accvgpr_write_b32 a30, v228
    v_mfma_f32_16x16x32_bf16 v[156:159], a[124:127], a[12:15], v[156:159]
    v_lshlrev_b32 v230, 16, v47
    v_and_b32 v231, s63, v47
    v_mul_f32 v230, s36, v230
    v_mul_f32 v231, s36, v231
    v_cvt_pk_bf16_f32 v230, v230, v231
    v_accvgpr_write_b32 a31, v230
    v_max3_f32 v241, v144, v145, v146
    v_max3_f32 v241, v241, v147, v148
    v_max3_f32 v241, v241, v149, v150
    v_max3_f32 v241, v241, v151, v152
    v_max3_f32 v241, v241, v153, v154
    v_max3_f32 v241, v241, v155, v156
    v_max3_f32 v241, v241, v157, v158
    v_max_f32 v241, v241, v159
    v_mov_b32 v242, v241
    s_nop 1
    v_permlane32_swap_b32 v241, v242
    v_max_f32 v241, v241, v242
    v_mov_b32 v242, v241
    s_nop 1
    v_permlane16_swap_b32 v241, v242
    v_max_f32 v241, v241, v242
    v_sub_f32 v144, v144, v241
    v_sub_f32 v145, v145, v241
    v_sub_f32 v146, v146, v241
    v_sub_f32 v147, v147, v241
    v_sub_f32 v148, v148, v241
    v_sub_f32 v149, v149, v241
    v_sub_f32 v150, v150, v241
    v_sub_f32 v151, v151, v241
    v_sub_f32 v152, v152, v241
    v_sub_f32 v153, v153, v241
    v_sub_f32 v154, v154, v241
    v_sub_f32 v155, v155, v241
    v_sub_f32 v156, v156, v241
    v_sub_f32 v157, v157, v241
    v_sub_f32 v158, v158, v241
    v_sub_f32 v159, v159, v241
    v_exp_f32 v144, v144
    v_exp_f32 v145, v145
    v_exp_f32 v146, v146
    v_perm_b32 v144, v145, v144, s27
    v_exp_f32 v147, v147
    v_exp_f32 v148, v148
    v_perm_b32 v145, v147, v146, s27
    v_exp_f32 v149, v149
    v_exp_f32 v150, v150
    v_perm_b32 v146, v149, v148, s27
    v_exp_f32 v151, v151
    v_exp_f32 v152, v152
    v_perm_b32 v147, v151, v150, s27
    v_exp_f32 v153, v153
    v_exp_f32 v154, v154
    v_perm_b32 v148, v153, v152, s27
    v_exp_f32 v155, v155
    v_exp_f32 v156, v156
    v_perm_b32 v149, v155, v154, s27
    v_exp_f32 v157, v157
    v_exp_f32 v158, v158
    v_perm_b32 v150, v157, v156, s27
    v_exp_f32 v159, v159
    v_sub_f32 v160, 0, v241
    v_sub_f32 v161, 0, v241
    v_sub_f32 v162, 0, v241
    v_sub_f32 v163, 0, v241
    v_perm_b32 v151, v159, v158, s27
    s_waitcnt vmcnt(4)
    s_barrier
    s_add_u32 m0, s21, 32768
    s_add_u32 s38, s21, 16384
    buffer_load_dwordx4 v208, s[4:7], s38 offen offset:0 sc0 sc1 nt lds
    buffer_load_dwordx4 v209, s[4:7], s38 offen offset:1024 sc0 sc1 nt lds
    buffer_load_dwordx4 v210, s[4:7], s38 offen offset:2048 sc0 sc1 nt lds
    buffer_load_dwordx4 v211, s[4:7], s38 offen offset:3072 sc0 sc1 nt lds
    ds_read_b64_tr_b16 a[128:129], v196 offset:16384
    ds_read_b64_tr_b16 a[130:131], v196 offset:20480
    ds_read_b64_tr_b16 a[132:133], v196 offset:24576
    ds_read_b64_tr_b16 a[134:135], v196 offset:28672
    ds_read_b64_tr_b16 a[136:137], v197 offset:16384
    ds_read_b64_tr_b16 a[138:139], v197 offset:20480
    ds_read_b64_tr_b16 a[140:141], v197 offset:24576
    ds_read_b64_tr_b16 a[142:143], v197 offset:28672
    ds_read_b64_tr_b16 a[144:145], v198 offset:16384
    ds_read_b64_tr_b16 a[146:147], v198 offset:20480
    ds_read_b64_tr_b16 a[148:149], v198 offset:24576
    ds_read_b64_tr_b16 a[150:151], v198 offset:28672
    ds_read_b64_tr_b16 a[152:153], v199 offset:16384
    ds_read_b64_tr_b16 a[154:155], v199 offset:20480
    ds_read_b64_tr_b16 a[156:157], v199 offset:24576
    ds_read_b64_tr_b16 a[158:159], v199 offset:28672
    ds_read_b64_tr_b16 a[160:161], v200 offset:16384
    ds_read_b64_tr_b16 a[162:163], v200 offset:20480
    ds_read_b64_tr_b16 a[164:165], v200 offset:24576
    ds_read_b64_tr_b16 a[166:167], v200 offset:28672
    ds_read_b64_tr_b16 a[168:169], v201 offset:16384
    ds_read_b64_tr_b16 a[170:171], v201 offset:20480
    ds_read_b64_tr_b16 a[172:173], v201 offset:24576
    ds_read_b64_tr_b16 a[174:175], v201 offset:28672
    ds_read_b64_tr_b16 a[176:177], v202 offset:16384
    ds_read_b64_tr_b16 a[178:179], v202 offset:20480
    ds_read_b64_tr_b16 a[180:181], v202 offset:24576
    ds_read_b64_tr_b16 a[182:183], v202 offset:28672
    ds_read_b64_tr_b16 a[184:185], v203 offset:16384
    ds_read_b64_tr_b16 a[186:187], v203 offset:20480
    ds_read_b64_tr_b16 a[188:189], v203 offset:24576
    ds_read_b64_tr_b16 a[190:191], v203 offset:28672
    s_waitcnt vmcnt(4)
    ds_read_b128 v[64:67], v248 offset:8192
    ds_read_b128 v[68:71], v249 offset:8192
    ds_read_b128 v[72:75], v250 offset:8192
    ds_read_b128 v[76:79], v251 offset:8192
    s_add_u32 m0, s21, 49152
    s_add_u32 s38, s21, 16384
    buffer_load_dwordx4 v212, s[8:11], s38 offen offset:0 sc0 sc1 nt lds
    buffer_load_dwordx4 v213, s[8:11], s38 offen offset:1024 sc0 sc1 nt lds
    buffer_load_dwordx4 v212, s[8:11], s38 offen offset:2048 sc0 sc1 nt lds
    buffer_load_dwordx4 v213, s[8:11], s38 offen offset:3072 sc0 sc1 nt lds
    s_waitcnt lgkmcnt(0)
    v_mfma_f32_16x16x32_bf16 v[128:131], a[64:67], a[16:19], 0
    v_lshlrev_b32 v224, 16, v64
    v_and_b32 v225, s63, v64
    v_mul_f32 v224, s36, v224
    v_mul_f32 v225, s36, v225
    v_cvt_pk_bf16_f32 v224, v224, v225
    v_accvgpr_write_b32 a32, v224
    v_mfma_f32_16x16x32_bf16 v[128:131], a[68:71], a[20:23], v[128:131]
    v_lshlrev_b32 v226, 16, v65
    v_and_b32 v227, s63, v65
    v_mul_f32 v226, s36, v226
    v_mul_f32 v227, s36, v227
    v_cvt_pk_bf16_f32 v226, v226, v227
    v_accvgpr_write_b32 a33, v226
    v_mfma_f32_16x16x32_bf16 v[128:131], a[72:75], a[24:27], v[128:131]
    v_lshlrev_b32 v228, 16, v66
    v_and_b32 v229, s63, v66
    v_mul_f32 v228, s36, v228
    v_mul_f32 v229, s36, v229
    v_cvt_pk_bf16_f32 v228, v228, v229
    v_accvgpr_write_b32 a34, v228
    v_mfma_f32_16x16x32_bf16 v[128:131], a[76:79], a[28:31], v[128:131]
    v_lshlrev_b32 v230, 16, v67
    v_and_b32 v231, s63, v67
    v_mul_f32 v230, s36, v230
    v_mul_f32 v231, s36, v231
    v_cvt_pk_bf16_f32 v230, v230, v231
    v_accvgpr_write_b32 a35, v230
    v_mfma_f32_16x16x32_bf16 v[132:135], a[80:83], a[16:19], 0
    v_lshlrev_b32 v224, 16, v68
    v_and_b32 v225, s63, v68
    v_mul_f32 v224, s36, v224
    v_mul_f32 v225, s36, v225
    v_cvt_pk_bf16_f32 v224, v224, v225
    v_accvgpr_write_b32 a36, v224
    v_mfma_f32_16x16x32_bf16 v[132:135], a[84:87], a[20:23], v[132:135]
    v_lshlrev_b32 v226, 16, v69
    v_and_b32 v227, s63, v69
    v_mul_f32 v226, s36, v226
    v_mul_f32 v227, s36, v227
    v_cvt_pk_bf16_f32 v226, v226, v227
    v_accvgpr_write_b32 a37, v226
    v_mfma_f32_16x16x32_bf16 v[132:135], a[88:91], a[24:27], v[132:135]
    v_lshlrev_b32 v228, 16, v70
    v_and_b32 v229, s63, v70
    v_mul_f32 v228, s36, v228
    v_mul_f32 v229, s36, v229
    v_cvt_pk_bf16_f32 v228, v228, v229
    v_accvgpr_write_b32 a38, v228
    v_mfma_f32_16x16x32_bf16 v[132:135], a[92:95], a[28:31], v[132:135]
    v_lshlrev_b32 v230, 16, v71
    v_and_b32 v231, s63, v71
    v_mul_f32 v230, s36, v230
    v_mul_f32 v231, s36, v231
    v_cvt_pk_bf16_f32 v230, v230, v231
    v_accvgpr_write_b32 a39, v230
    v_mfma_f32_16x16x32_bf16 v[136:139], a[96:99], a[16:19], 0
    v_lshlrev_b32 v224, 16, v72
    v_and_b32 v225, s63, v72
    v_mul_f32 v224, s36, v224
    v_mul_f32 v225, s36, v225
    v_cvt_pk_bf16_f32 v224, v224, v225
    v_accvgpr_write_b32 a40, v224
    v_mfma_f32_16x16x32_bf16 v[136:139], a[100:103], a[20:23], v[136:139]
    v_lshlrev_b32 v226, 16, v73
    v_and_b32 v227, s63, v73
    v_mul_f32 v226, s36, v226
    v_mul_f32 v227, s36, v227
    v_cvt_pk_bf16_f32 v226, v226, v227
    v_accvgpr_write_b32 a41, v226
    v_mfma_f32_16x16x32_bf16 v[136:139], a[104:107], a[24:27], v[136:139]
    v_lshlrev_b32 v228, 16, v74
    v_and_b32 v229, s63, v74
    v_mul_f32 v228, s36, v228
    v_mul_f32 v229, s36, v229
    v_cvt_pk_bf16_f32 v228, v228, v229
    v_accvgpr_write_b32 a42, v228
    v_mfma_f32_16x16x32_bf16 v[136:139], a[108:111], a[28:31], v[136:139]
    v_lshlrev_b32 v230, 16, v75
    v_and_b32 v231, s63, v75
    v_mul_f32 v230, s36, v230
    v_mul_f32 v231, s36, v231
    v_cvt_pk_bf16_f32 v230, v230, v231
    v_accvgpr_write_b32 a43, v230
    v_mfma_f32_16x16x32_bf16 v[140:143], a[112:115], a[16:19], 0
    v_lshlrev_b32 v224, 16, v76
    v_and_b32 v225, s63, v76
    v_mul_f32 v224, s36, v224
    v_mul_f32 v225, s36, v225
    v_cvt_pk_bf16_f32 v224, v224, v225
    v_accvgpr_write_b32 a44, v224
    v_mfma_f32_16x16x32_bf16 v[140:143], a[116:119], a[20:23], v[140:143]
    v_lshlrev_b32 v226, 16, v77
    v_and_b32 v227, s63, v77
    v_mul_f32 v226, s36, v226
    v_mul_f32 v227, s36, v227
    v_cvt_pk_bf16_f32 v226, v226, v227
    v_accvgpr_write_b32 a45, v226
    v_mfma_f32_16x16x32_bf16 v[140:143], a[120:123], a[24:27], v[140:143]
    v_lshlrev_b32 v228, 16, v78
    v_and_b32 v229, s63, v78
    v_mul_f32 v228, s36, v228
    v_mul_f32 v229, s36, v229
    v_cvt_pk_bf16_f32 v228, v228, v229
    v_accvgpr_write_b32 a46, v228
    v_mfma_f32_16x16x32_bf16 v[140:143], a[124:127], a[28:31], v[140:143]
    v_lshlrev_b32 v230, 16, v79
    v_and_b32 v231, s63, v79
    v_mul_f32 v230, s36, v230
    v_mul_f32 v231, s36, v231
    v_cvt_pk_bf16_f32 v230, v230, v231
    v_accvgpr_write_b32 a47, v230
    v_smfmac_f32_16x16x64_bf16 v[176:179], v[204:207], v[144:151], v220
    v_mfma_f32_16x16x32_bf16 v[0:3], a[128:131], v[144:147], 0
    v_mfma_f32_16x16x32_bf16 v[0:3], a[132:135], v[148:151], v[0:3]
    v_mfma_f32_16x16x32_bf16 v[4:7], a[136:139], v[144:147], 0
    v_max3_f32 v241, v128, v129, v130
    v_max3_f32 v241, v241, v131, v132
    v_max3_f32 v241, v241, v133, v134
    v_max3_f32 v241, v241, v135, v136
    v_max3_f32 v241, v241, v137, v138
    v_mfma_f32_16x16x32_bf16 v[4:7], a[140:143], v[148:151], v[4:7]
    v_max3_f32 v241, v241, v139, v140
    v_max3_f32 v241, v241, v141, v142
    v_max_f32 v241, v241, v143
    v_mov_b32 v242, v241
    s_nop 1
    v_mfma_f32_16x16x32_bf16 v[8:11], a[144:147], v[144:147], 0
    v_permlane32_swap_b32 v241, v242
    v_max_f32 v241, v241, v242
    v_mov_b32 v242, v241
    s_nop 1
    v_permlane16_swap_b32 v241, v242
    v_mfma_f32_16x16x32_bf16 v[8:11], a[148:151], v[148:151], v[8:11]
    v_max_f32 v241, v241, v242
    v_sub_f32 v128, v128, v241
    v_sub_f32 v129, v129, v241
    v_sub_f32 v130, v130, v241
    v_sub_f32 v131, v131, v241
    v_mfma_f32_16x16x32_bf16 v[12:15], a[152:155], v[144:147], 0
    v_sub_f32 v132, v132, v241
    v_sub_f32 v133, v133, v241
    v_sub_f32 v134, v134, v241
    v_sub_f32 v135, v135, v241
    v_mfma_f32_16x16x32_bf16 v[12:15], a[156:159], v[148:151], v[12:15]
    v_sub_f32 v136, v136, v241
    v_sub_f32 v137, v137, v241
    v_sub_f32 v138, v138, v241
    v_sub_f32 v139, v139, v241
    v_mfma_f32_16x16x32_bf16 v[16:19], a[160:163], v[144:147], 0
    v_sub_f32 v140, v140, v241
    v_sub_f32 v141, v141, v241
    v_sub_f32 v142, v142, v241
    v_sub_f32 v143, v143, v241
    v_mfma_f32_16x16x32_bf16 v[16:19], a[164:167], v[148:151], v[16:19]
    v_exp_f32 v128, v128
    v_exp_f32 v129, v129
    v_exp_f32 v130, v130
    v_perm_b32 v128, v129, v128, s27
    v_mfma_f32_16x16x32_bf16 v[20:23], a[168:171], v[144:147], 0
    v_exp_f32 v131, v131
    v_exp_f32 v132, v132
    v_perm_b32 v129, v131, v130, s27
    v_exp_f32 v133, v133
    v_mfma_f32_16x16x32_bf16 v[20:23], a[172:175], v[148:151], v[20:23]
    v_exp_f32 v134, v134
    v_perm_b32 v130, v133, v132, s27
    v_exp_f32 v135, v135
    v_exp_f32 v136, v136
    v_mfma_f32_16x16x32_bf16 v[24:27], a[176:179], v[144:147], 0
    v_perm_b32 v131, v135, v134, s27
    v_exp_f32 v137, v137
    v_exp_f32 v138, v138
    v_perm_b32 v132, v137, v136, s27
    v_mfma_f32_16x16x32_bf16 v[24:27], a[180:183], v[148:151], v[24:27]
    v_exp_f32 v139, v139
    v_exp_f32 v140, v140
    v_perm_b32 v133, v139, v138, s27
    v_exp_f32 v141, v141
    v_mfma_f32_16x16x32_bf16 v[28:31], a[184:187], v[144:147], 0
    v_exp_f32 v142, v142
    v_perm_b32 v134, v141, v140, s27
    v_exp_f32 v143, v143
    v_sub_f32 v164, 0, v241
    v_mfma_f32_16x16x32_bf16 v[28:31], a[188:191], v[148:151], v[28:31]
    v_sub_f32 v165, 0, v241
    v_sub_f32 v166, 0, v241
    v_sub_f32 v167, 0, v241
    v_perm_b32 v135, v143, v142, s27
    s_nop 0
    v_mfma_f32_16x16x32_bf16 v[144:147], a[64:67], a[32:35], 0
    s_mov_b32 s38, 32768
    s_mov_b32 m0, 65536
    v_mfma_f32_16x16x32_bf16 v[144:147], a[68:71], a[36:39], v[144:147]
    s_nop 0
    buffer_load_dwordx4 v208, s[4:7], s38 offen offset:0 sc0 sc1 nt lds
    v_mfma_f32_16x16x32_bf16 v[144:147], a[72:75], a[40:43], v[144:147]
    buffer_load_dwordx4 v209, s[4:7], s38 offen offset:1024 sc0 sc1 nt lds
    buffer_load_dwordx4 v210, s[4:7], s38 offen offset:2048 sc0 sc1 nt lds
    v_mfma_f32_16x16x32_bf16 v[144:147], a[76:79], a[44:47], v[144:147]
    buffer_load_dwordx4 v211, s[4:7], s38 offen offset:3072 sc0 sc1 nt lds
    s_mov_b32 m0, 69632
    v_mfma_f32_16x16x32_bf16 v[148:151], a[80:83], a[32:35], 0
    s_nop 0
    buffer_load_dwordx4 v96, s[4:7], s38 offen offset:0 sc0 sc1 nt lds
    v_mfma_f32_16x16x32_bf16 v[148:151], a[84:87], a[36:39], v[148:151]
    buffer_load_dwordx4 v97, s[4:7], s38 offen offset:1024 sc0 sc1 nt lds
    buffer_load_dwordx4 v98, s[4:7], s38 offen offset:2048 sc0 sc1 nt lds
    v_mfma_f32_16x16x32_bf16 v[148:151], a[88:91], a[40:43], v[148:151]
    buffer_load_dwordx4 v99, s[4:7], s38 offen offset:3072 sc0 sc1 nt lds
    s_mov_b32 m0, 73728
    v_mfma_f32_16x16x32_bf16 v[148:151], a[92:95], a[44:47], v[148:151]
    s_nop 0
    buffer_load_dwordx4 v100, s[4:7], s38 offen offset:0 sc0 sc1 nt lds
    v_mfma_f32_16x16x32_bf16 v[152:155], a[96:99], a[32:35], 0
    buffer_load_dwordx4 v101, s[4:7], s38 offen offset:1024 sc0 sc1 nt lds
    buffer_load_dwordx4 v102, s[4:7], s38 offen offset:2048 sc0 sc1 nt lds
    v_mfma_f32_16x16x32_bf16 v[152:155], a[100:103], a[36:39], v[152:155]
    buffer_load_dwordx4 v103, s[4:7], s38 offen offset:3072 sc0 sc1 nt lds
    v_mfma_f32_16x16x32_bf16 v[152:155], a[104:107], a[40:43], v[152:155]
    s_mov_b32 m0, 77824
    v_mfma_f32_16x16x32_bf16 v[152:155], a[108:111], a[44:47], v[152:155]
    s_nop 0
    v_mfma_f32_16x16x32_bf16 v[156:159], a[112:115], a[32:35], 0
    buffer_load_dwordx4 v104, s[4:7], s38 offen offset:0 sc0 sc1 nt lds
    v_mfma_f32_16x16x32_bf16 v[156:159], a[116:119], a[36:39], v[156:159]
    buffer_load_dwordx4 v105, s[4:7], s38 offen offset:1024 sc0 sc1 nt lds
    v_mfma_f32_16x16x32_bf16 v[156:159], a[120:123], a[40:43], v[156:159]
    buffer_load_dwordx4 v106, s[4:7], s38 offen offset:2048 sc0 sc1 nt lds
    v_mfma_f32_16x16x32_bf16 v[156:159], a[124:127], a[44:47], v[156:159]
    buffer_load_dwordx4 v107, s[4:7], s38 offen offset:3072 sc0 sc1 nt lds
    s_waitcnt vmcnt(20)
    s_barrier
    ds_read_b128 a[64:67], v192 offset:32768
    ds_read_b128 a[68:71], v193 offset:32768
    ds_read_b128 a[72:75], v194 offset:32768
    ds_read_b128 a[76:79], v195 offset:32768
    ds_read_b128 a[80:83], v192 offset:36864
    ds_read_b128 a[84:87], v193 offset:36864
    ds_read_b128 a[88:91], v194 offset:36864
    ds_read_b128 a[92:95], v195 offset:36864
    ds_read_b128 a[96:99], v192 offset:40960
    ds_read_b128 a[100:103], v193 offset:40960
    ds_read_b128 a[104:107], v194 offset:40960
    ds_read_b128 a[108:111], v195 offset:40960
    ds_read_b128 a[112:115], v192 offset:45056
    ds_read_b128 a[116:119], v193 offset:45056
    ds_read_b128 a[120:123], v194 offset:45056
    ds_read_b128 a[124:127], v195 offset:45056
    v_smfmac_f32_16x16x64_bf16 v[180:183], v[204:207], v[128:135], v220
    v_mfma_f32_16x16x32_bf16 v[32:35], a[128:131], v[128:131], 0
    v_mfma_f32_16x16x32_bf16 v[32:35], a[132:135], v[132:135], v[32:35]
    v_mfma_f32_16x16x32_bf16 v[36:39], a[136:139], v[128:131], 0
    v_max3_f32 v241, v144, v145, v146
    v_max3_f32 v241, v241, v147, v148
    v_max3_f32 v241, v241, v149, v150
    v_max3_f32 v241, v241, v151, v152
    v_max3_f32 v241, v241, v153, v154
    v_mfma_f32_16x16x32_bf16 v[36:39], a[140:143], v[132:135], v[36:39]
    v_max3_f32 v241, v241, v155, v156
    v_max3_f32 v241, v241, v157, v158
    v_max_f32 v241, v241, v159
    v_mov_b32 v242, v241
    s_nop 1
    v_mfma_f32_16x16x32_bf16 v[40:43], a[144:147], v[128:131], 0
    v_permlane32_swap_b32 v241, v242
    v_max_f32 v241, v241, v242
    v_mov_b32 v242, v241
    s_nop 1
    v_permlane16_swap_b32 v241, v242
    v_mfma_f32_16x16x32_bf16 v[40:43], a[148:151], v[132:135], v[40:43]
    v_max_f32 v241, v241, v242
    v_sub_f32 v144, v144, v241
    v_sub_f32 v145, v145, v241
    v_sub_f32 v146, v146, v241
    v_sub_f32 v147, v147, v241
    v_mfma_f32_16x16x32_bf16 v[44:47], a[152:155], v[128:131], 0
    v_sub_f32 v148, v148, v241
    v_sub_f32 v149, v149, v241
    v_sub_f32 v150, v150, v241
    v_sub_f32 v151, v151, v241
    v_mfma_f32_16x16x32_bf16 v[44:47], a[156:159], v[132:135], v[44:47]
    v_sub_f32 v152, v152, v241
    v_sub_f32 v153, v153, v241
    v_sub_f32 v154, v154, v241
    v_sub_f32 v155, v155, v241
    v_mfma_f32_16x16x32_bf16 v[48:51], a[160:163], v[128:131], 0
    v_sub_f32 v156, v156, v241
    v_sub_f32 v157, v157, v241
    v_sub_f32 v158, v158, v241
    v_sub_f32 v159, v159, v241
    v_mfma_f32_16x16x32_bf16 v[48:51], a[164:167], v[132:135], v[48:51]
    v_exp_f32 v144, v144
    v_exp_f32 v145, v145
    v_exp_f32 v146, v146
    v_perm_b32 v144, v145, v144, s27
    v_mfma_f32_16x16x32_bf16 v[52:55], a[168:171], v[128:131], 0
    v_exp_f32 v147, v147
    v_exp_f32 v148, v148
    v_perm_b32 v145, v147, v146, s27
    v_exp_f32 v149, v149
    v_mfma_f32_16x16x32_bf16 v[52:55], a[172:175], v[132:135], v[52:55]
    v_exp_f32 v150, v150
    v_perm_b32 v146, v149, v148, s27
    v_exp_f32 v151, v151
    v_exp_f32 v152, v152
    v_mfma_f32_16x16x32_bf16 v[56:59], a[176:179], v[128:131], 0
    v_perm_b32 v147, v151, v150, s27
    v_exp_f32 v153, v153
    v_exp_f32 v154, v154
    v_perm_b32 v148, v153, v152, s27
    v_mfma_f32_16x16x32_bf16 v[56:59], a[180:183], v[132:135], v[56:59]
    v_exp_f32 v155, v155
    v_exp_f32 v156, v156
    v_perm_b32 v149, v155, v154, s27
    v_exp_f32 v157, v157
    v_mfma_f32_16x16x32_bf16 v[60:63], a[184:187], v[128:131], 0
    v_exp_f32 v158, v158
    v_perm_b32 v150, v157, v156, s27
    v_exp_f32 v159, v159
    v_sub_f32 v168, 0, v241
    v_mfma_f32_16x16x32_bf16 v[60:63], a[188:191], v[132:135], v[60:63]
    v_sub_f32 v169, 0, v241
    v_sub_f32 v170, 0, v241
    v_sub_f32 v171, 0, v241
    v_perm_b32 v151, v159, v158, s27
    s_waitcnt lgkmcnt(0)
    v_mfma_f32_16x16x32_bf16 v[128:131], a[64:67], a[0:3], v[160:163]
    s_mov_b32 s38, 32768
    s_mov_b32 m0, 81920
    v_mfma_f32_16x16x32_bf16 v[128:131], a[68:71], a[4:7], v[128:131]
    s_nop 0
    buffer_load_dwordx4 v212, s[8:11], s38 offen offset:0 sc0 sc1 nt lds
    v_mfma_f32_16x16x32_bf16 v[128:131], a[72:75], a[8:11], v[128:131]
    buffer_load_dwordx4 v213, s[8:11], s38 offen offset:1024 sc0 sc1 nt lds
    buffer_load_dwordx4 v212, s[8:11], s38 offen offset:2048 sc0 sc1 nt lds
    v_mfma_f32_16x16x32_bf16 v[128:131], a[76:79], a[12:15], v[128:131]
    buffer_load_dwordx4 v213, s[8:11], s38 offen offset:3072 sc0 sc1 nt lds
    s_mov_b32 m0, 86016
    v_mfma_f32_16x16x32_bf16 v[132:135], a[80:83], a[0:3], v[160:163]
    s_nop 0
    buffer_load_dwordx4 v108, s[8:11], s38 offen offset:0 sc0 sc1 nt lds
    v_mfma_f32_16x16x32_bf16 v[132:135], a[84:87], a[4:7], v[132:135]
    buffer_load_dwordx4 v109, s[8:11], s38 offen offset:1024 sc0 sc1 nt lds
    buffer_load_dwordx4 v108, s[8:11], s38 offen offset:2048 sc0 sc1 nt lds
    s_nop 0
    v_mfma_f32_16x16x32_bf16 v[132:135], a[88:91], a[8:11], v[132:135]
    buffer_load_dwordx4 v109, s[8:11], s38 offen offset:3072 sc0 sc1 nt lds
    s_mov_b32 m0, 90112
    v_mfma_f32_16x16x32_bf16 v[132:135], a[92:95], a[12:15], v[132:135]
    s_nop 0
    buffer_load_dwordx4 v110, s[8:11], s38 offen offset:0 sc0 sc1 nt lds
    v_mfma_f32_16x16x32_bf16 v[136:139], a[96:99], a[0:3], v[160:163]
    buffer_load_dwordx4 v111, s[8:11], s38 offen offset:1024 sc0 sc1 nt lds
    buffer_load_dwordx4 v110, s[8:11], s38 offen offset:2048 sc0 sc1 nt lds
    v_mfma_f32_16x16x32_bf16 v[136:139], a[100:103], a[4:7], v[136:139]
    buffer_load_dwordx4 v111, s[8:11], s38 offen offset:3072 sc0 sc1 nt lds
    s_mov_b32 m0, 94208
    v_mfma_f32_16x16x32_bf16 v[136:139], a[104:107], a[8:11], v[136:139]
    s_nop 0
    buffer_load_dwordx4 v112, s[8:11], s38 offen offset:0 sc0 sc1 nt lds
    v_exp_f32 v128, v128
    v_mfma_f32_16x16x32_bf16 v[136:139], a[108:111], a[12:15], v[136:139]
    buffer_load_dwordx4 v113, s[8:11], s38 offen offset:1024 sc0 sc1 nt lds
    buffer_load_dwordx4 v112, s[8:11], s38 offen offset:2048 sc0 sc1 nt lds
    v_mfma_f32_16x16x32_bf16 v[140:143], a[112:115], a[0:3], v[160:163]
    buffer_load_dwordx4 v113, s[8:11], s38 offen offset:3072 sc0 sc1 nt lds
    s_mov_b32 s38, 49152
    v_exp_f32 v129, v129
    v_mfma_f32_16x16x32_bf16 v[140:143], a[116:119], a[4:7], v[140:143]
    s_mov_b32 m0, 98304
    s_nop 0
    v_perm_b32 v128, v129, v128, s27
    v_mfma_f32_16x16x32_bf16 v[140:143], a[120:123], a[8:11], v[140:143]
    buffer_load_dwordx4 v208, s[4:7], s38 offen offset:0 sc0 sc1 nt lds
    buffer_load_dwordx4 v209, s[4:7], s38 offen offset:1024 sc0 sc1 nt lds
    v_exp_f32 v130, v130
    v_mfma_f32_16x16x32_bf16 v[140:143], a[124:127], a[12:15], v[140:143]
    buffer_load_dwordx4 v210, s[4:7], s38 offen offset:2048 sc0 sc1 nt lds
    buffer_load_dwordx4 v211, s[4:7], s38 offen offset:3072 sc0 sc1 nt lds
    v_smfmac_f32_16x16x64_bf16 v[184:187], v[204:207], v[144:151], v220
    s_mov_b32 m0, 102400
    s_nop 0
    v_exp_f32 v131, v131
    v_mfma_f32_16x16x32_bf16 v[64:67], a[128:131], v[144:147], 0
    buffer_load_dwordx4 v96, s[4:7], s38 offen offset:0 sc0 sc1 nt lds
    v_perm_b32 v129, v131, v130, s27
    v_mfma_f32_16x16x32_bf16 v[64:67], a[132:135], v[148:151], v[64:67]
    buffer_load_dwordx4 v97, s[4:7], s38 offen offset:1024 sc0 sc1 nt lds
    v_exp_f32 v132, v132
    v_mfma_f32_16x16x32_bf16 v[68:71], a[136:139], v[144:147], 0
    buffer_load_dwordx4 v98, s[4:7], s38 offen offset:2048 sc0 sc1 nt lds
    v_mfma_f32_16x16x32_bf16 v[68:71], a[140:143], v[148:151], v[68:71]
    buffer_load_dwordx4 v99, s[4:7], s38 offen offset:3072 sc0 sc1 nt lds
    v_exp_f32 v133, v133
    v_mfma_f32_16x16x32_bf16 v[72:75], a[144:147], v[144:147], 0
    s_mov_b32 m0, 106496
    v_perm_b32 v130, v133, v132, s27
    v_mfma_f32_16x16x32_bf16 v[72:75], a[148:151], v[148:151], v[72:75]
    s_nop 0
    v_exp_f32 v134, v134
    v_mfma_f32_16x16x32_bf16 v[76:79], a[152:155], v[144:147], 0
    buffer_load_dwordx4 v100, s[4:7], s38 offen offset:0 sc0 sc1 nt lds
    v_mfma_f32_16x16x32_bf16 v[76:79], a[156:159], v[148:151], v[76:79]
    buffer_load_dwordx4 v101, s[4:7], s38 offen offset:1024 sc0 sc1 nt lds
    v_exp_f32 v135, v135
    v_mfma_f32_16x16x32_bf16 v[80:83], a[160:163], v[144:147], 0
    buffer_load_dwordx4 v102, s[4:7], s38 offen offset:2048 sc0 sc1 nt lds
    v_perm_b32 v131, v135, v134, s27
    v_mfma_f32_16x16x32_bf16 v[80:83], a[164:167], v[148:151], v[80:83]
    buffer_load_dwordx4 v103, s[4:7], s38 offen offset:3072 sc0 sc1 nt lds
    v_exp_f32 v136, v136
    v_mfma_f32_16x16x32_bf16 v[84:87], a[168:171], v[144:147], 0
    s_mov_b32 m0, 110592
    v_mfma_f32_16x16x32_bf16 v[84:87], a[172:175], v[148:151], v[84:87]
    s_nop 0
    v_exp_f32 v137, v137
    v_mfma_f32_16x16x32_bf16 v[88:91], a[176:179], v[144:147], 0
    buffer_load_dwordx4 v104, s[4:7], s38 offen offset:0 sc0 sc1 nt lds
    v_perm_b32 v132, v137, v136, s27
    v_mfma_f32_16x16x32_bf16 v[88:91], a[180:183], v[148:151], v[88:91]
    buffer_load_dwordx4 v105, s[4:7], s38 offen offset:1024 sc0 sc1 nt lds
    v_exp_f32 v138, v138
    v_mfma_f32_16x16x32_bf16 v[92:95], a[184:187], v[144:147], 0
    buffer_load_dwordx4 v106, s[4:7], s38 offen offset:2048 sc0 sc1 nt lds
    v_mfma_f32_16x16x32_bf16 v[92:95], a[188:191], v[148:151], v[92:95]
    buffer_load_dwordx4 v107, s[4:7], s38 offen offset:3072 sc0 sc1 nt lds
    v_exp_f32 v139, v139
    s_waitcnt vmcnt(48)
    s_barrier
    s_mov_b32 s23, 49152
    s_mov_b32 s22, 65536
    s_mov_b32 s25, 114688
    s_mov_b32 s24, 0
    ds_read_b64_tr_b16 a[192:193], v196 offset:49152
    ds_read_b64_tr_b16 a[194:195], v196 offset:53248
    ds_read_b64_tr_b16 a[196:197], v196 offset:57344
    ds_read_b64_tr_b16 a[198:199], v196 offset:61440
    ds_read_b64_tr_b16 a[200:201], v197 offset:49152
    ds_read_b64_tr_b16 a[202:203], v197 offset:53248
    ds_read_b64_tr_b16 a[204:205], v197 offset:57344
    ds_read_b64_tr_b16 a[206:207], v197 offset:61440
    ds_read_b64_tr_b16 a[208:209], v198 offset:49152
    ds_read_b64_tr_b16 a[210:211], v198 offset:53248
    ds_read_b64_tr_b16 a[212:213], v198 offset:57344
    ds_read_b64_tr_b16 a[214:215], v198 offset:61440
    ds_read_b64_tr_b16 a[216:217], v199 offset:49152
    ds_read_b64_tr_b16 a[218:219], v199 offset:53248
    ds_read_b64_tr_b16 a[220:221], v199 offset:57344
    ds_read_b64_tr_b16 a[222:223], v199 offset:61440
    ds_read_b64_tr_b16 a[224:225], v200 offset:49152
    ds_read_b64_tr_b16 a[226:227], v200 offset:53248
    ds_read_b64_tr_b16 a[228:229], v200 offset:57344
    ds_read_b64_tr_b16 a[230:231], v200 offset:61440
    ds_read_b64_tr_b16 a[232:233], v201 offset:49152
    ds_read_b64_tr_b16 a[234:235], v201 offset:53248
    ds_read_b64_tr_b16 a[236:237], v201 offset:57344
    ds_read_b64_tr_b16 a[238:239], v201 offset:61440
    ds_read_b64_tr_b16 a[240:241], v202 offset:49152
    ds_read_b64_tr_b16 a[242:243], v202 offset:53248
    s_add_u32 m0, s25, 0
    s_nop 0
    buffer_load_dwordx4 v212, s[8:11], s23 offen offset:0 sc0 sc1 nt lds
    s_add_u32 s26, s26, 1
    buffer_load_dwordx4 v213, s[8:11], s23 offen offset:1024 sc0 sc1 nt lds
    buffer_load_dwordx4 v212, s[8:11], s23 offen offset:2048 sc0 sc1 nt lds
    buffer_load_dwordx4 v213, s[8:11], s23 offen offset:3072 sc0 sc1 nt lds
    s_add_u32 m0, s25, 4096
    s_nop 0
    buffer_load_dwordx4 v108, s[8:11], s23 offen offset:0 sc0 sc1 nt lds
    buffer_load_dwordx4 v109, s[8:11], s23 offen offset:1024 sc0 sc1 nt lds
    buffer_load_dwordx4 v108, s[8:11], s23 offen offset:2048 sc0 sc1 nt lds
    buffer_load_dwordx4 v109, s[8:11], s23 offen offset:3072 sc0 sc1 nt lds
    s_add_u32 m0, s25, 8192
    s_nop 0
    buffer_load_dwordx4 v110, s[8:11], s23 offen offset:0 sc0 sc1 nt lds
    buffer_load_dwordx4 v111, s[8:11], s23 offen offset:1024 sc0 sc1 nt lds
    buffer_load_dwordx4 v110, s[8:11], s23 offen offset:2048 sc0 sc1 nt lds
    buffer_load_dwordx4 v111, s[8:11], s23 offen offset:3072 sc0 sc1 nt lds
    s_add_u32 m0, s25, 12288
    s_nop 0
    buffer_load_dwordx4 v112, s[8:11], s23 offen offset:0 sc0 sc1 nt lds
    buffer_load_dwordx4 v113, s[8:11], s23 offen offset:1024 sc0 sc1 nt lds
    buffer_load_dwordx4 v112, s[8:11], s23 offen offset:2048 sc0 sc1 nt lds
    buffer_load_dwordx4 v113, s[8:11], s23 offen offset:3072 sc0 sc1 nt lds
    s_add_u32 s23, s23, 16384
    s_add_u32 s25, s24, 16384
    s_add_u32 m0, s24, 0
    s_nop 0
    buffer_load_dwordx4 v208, s[4:7], s22 offen offset:0 sc0 sc1 nt lds
    buffer_load_dwordx4 v209, s[4:7], s22 offen offset:1024 sc0 sc1 nt lds
    buffer_load_dwordx4 v210, s[4:7], s22 offen offset:2048 sc0 sc1 nt lds
    buffer_load_dwordx4 v211, s[4:7], s22 offen offset:3072 sc0 sc1 nt lds
    s_add_u32 m0, s24, 4096
    s_nop 0
    buffer_load_dwordx4 v96, s[4:7], s22 offen offset:0 sc0 sc1 nt lds
    buffer_load_dwordx4 v97, s[4:7], s22 offen offset:1024 sc0 sc1 nt lds
    buffer_load_dwordx4 v98, s[4:7], s22 offen offset:2048 sc0 sc1 nt lds
    s_getreg_b32 s64, hwreg(HW_REG_XCC_ID, 0, 1)
    s_cmp_eq_u32 s64, 1
    s_cselect_b32 s65, 5, 12
    s_cselect_b32 s66, 11, 16
    s_branch L_entryB3
L_tailA:
    v_mfma_f32_16x16x32_bf16 v[144:147], a[64:67], a[16:19], v[164:167]
    ds_read_b64_tr_b16 a[244:245], v202 offset:57344
    v_perm_b32 v133, v139, v138, s27
    v_mfma_f32_16x16x32_bf16 v[144:147], a[68:71], a[20:23], v[144:147]
    v_exp_f32 v140, v140
    v_mfma_f32_16x16x32_bf16 v[144:147], a[72:75], a[24:27], v[144:147]
    ds_read_b64_tr_b16 a[246:247], v202 offset:61440
    ds_read_b64_tr_b16 a[248:249], v203 offset:49152
    v_mfma_f32_16x16x32_bf16 v[144:147], a[76:79], a[28:31], v[144:147]
    v_exp_f32 v141, v141
    v_mfma_f32_16x16x32_bf16 v[148:151], a[80:83], a[16:19], v[164:167]
    ds_read_b64_tr_b16 a[250:251], v203 offset:53248
    v_perm_b32 v134, v141, v140, s27
    v_mfma_f32_16x16x32_bf16 v[148:151], a[84:87], a[20:23], v[148:151]
    v_exp_f32 v142, v142
    v_mfma_f32_16x16x32_bf16 v[148:151], a[88:91], a[24:27], v[148:151]
    ds_read_b64_tr_b16 a[252:253], v203 offset:57344
    ds_read_b64_tr_b16 a[254:255], v203 offset:61440
    v_mfma_f32_16x16x32_bf16 v[148:151], a[92:95], a[28:31], v[148:151]
    v_exp_f32 v143, v143
    v_mfma_f32_16x16x32_bf16 v[152:155], a[96:99], a[16:19], v[164:167]
    v_perm_b32 v135, v143, v142, s27
    s_lshl_b32 s42, s20, 14
    v_mfma_f32_16x16x32_bf16 v[152:155], a[100:103], a[20:23], v[152:155]
    s_add_u32 s43, s42, 4096
    v_mfma_f32_16x16x32_bf16 v[152:155], a[104:107], a[24:27], v[152:155]
    v_exp_f32 v144, v144
    v_mfma_f32_16x16x32_bf16 v[152:155], a[108:111], a[28:31], v[152:155]
    v_mfma_f32_16x16x32_bf16 v[156:159], a[112:115], a[16:19], v[164:167]
    v_exp_f32 v145, v145
    v_mfma_f32_16x16x32_bf16 v[156:159], a[116:119], a[20:23], v[156:159]
    v_perm_b32 v144, v145, v144, s27
    v_mfma_f32_16x16x32_bf16 v[156:159], a[120:123], a[24:27], v[156:159]
    v_exp_f32 v146, v146
    v_mfma_f32_16x16x32_bf16 v[156:159], a[124:127], a[28:31], v[156:159]
    v_smfmac_f32_16x16x64_bf16 v[176:179], v[204:207], v[128:135], v220
    v_exp_f32 v147, v147
    v_mfma_f32_16x16x32_bf16 v[0:3], a[192:195], v[128:131], v[0:3]
    v_perm_b32 v145, v147, v146, s27
    s_waitcnt lgkmcnt(0)
    v_mfma_f32_16x16x32_bf16 v[0:3], a[196:199], v[132:135], v[0:3]
    v_exp_f32 v148, v148
    v_mfma_f32_16x16x32_bf16 v[4:7], a[200:203], v[128:131], v[4:7]
    v_mfma_f32_16x16x32_bf16 v[4:7], a[204:207], v[132:135], v[4:7]
    v_exp_f32 v149, v149
    v_mfma_f32_16x16x32_bf16 v[8:11], a[208:211], v[128:131], v[8:11]
    v_perm_b32 v146, v149, v148, s27
    v_mfma_f32_16x16x32_bf16 v[8:11], a[212:215], v[132:135], v[8:11]
    v_exp_f32 v150, v150
    v_mfma_f32_16x16x32_bf16 v[12:15], a[216:219], v[128:131], v[12:15]
    v_mfma_f32_16x16x32_bf16 v[12:15], a[220:223], v[132:135], v[12:15]
    v_exp_f32 v151, v151
    v_mfma_f32_16x16x32_bf16 v[16:19], a[224:227], v[128:131], v[16:19]
    v_perm_b32 v147, v151, v150, s27
    v_mfma_f32_16x16x32_bf16 v[16:19], a[228:231], v[132:135], v[16:19]
    v_exp_f32 v152, v152
    v_mfma_f32_16x16x32_bf16 v[20:23], a[232:235], v[128:131], v[20:23]
    v_mfma_f32_16x16x32_bf16 v[20:23], a[236:239], v[132:135], v[20:23]
    v_exp_f32 v153, v153
    v_mfma_f32_16x16x32_bf16 v[24:27], a[240:243], v[128:131], v[24:27]
    v_perm_b32 v148, v153, v152, s27
    v_mfma_f32_16x16x32_bf16 v[24:27], a[244:247], v[132:135], v[24:27]
    v_exp_f32 v154, v154
    v_mfma_f32_16x16x32_bf16 v[28:31], a[248:251], v[128:131], v[28:31]
    v_mfma_f32_16x16x32_bf16 v[28:31], a[252:255], v[132:135], v[28:31]
    v_exp_f32 v155, v155
    v_mfma_f32_16x16x32_bf16 v[128:131], a[64:67], a[32:35], v[168:171]
    v_perm_b32 v149, v155, v154, s27
    v_mfma_f32_16x16x32_bf16 v[128:131], a[68:71], a[36:39], v[128:131]
    v_exp_f32 v156, v156
    v_mfma_f32_16x16x32_bf16 v[128:131], a[72:75], a[40:43], v[128:131]
    v_mfma_f32_16x16x32_bf16 v[128:131], a[76:79], a[44:47], v[128:131]
    v_exp_f32 v157, v157
    v_add_f32 v176, v176, v177
    v_rcp_f32 v224, v176
    s_nop 0
    v_mul_f32 v0, v0, v224
    v_mfma_f32_16x16x32_bf16 v[132:135], a[80:83], a[32:35], v[168:171]
    v_perm_b32 v150, v157, v156, s27
    v_mul_f32 v1, v1, v224
    v_mul_f32 v2, v2, v224
    v_mul_f32 v3, v3, v224
    v_cvt_pk_bf16_f32 v0, v0, v1
    v_cvt_pk_bf16_f32 v1, v2, v3
    v_mfma_f32_16x16x32_bf16 v[132:135], a[84:87], a[36:39], v[132:135]
    v_exp_f32 v158, v158
    v_mul_f32 v4, v4, v224
    v_mul_f32 v5, v5, v224
    v_mul_f32 v6, v6, v224
    v_mul_f32 v7, v7, v224
    v_mfma_f32_16x16x32_bf16 v[132:135], a[88:91], a[40:43], v[132:135]
    ds_write_b64 v232, v[0:1] offset:0
    v_cvt_pk_bf16_f32 v4, v4, v5
    v_cvt_pk_bf16_f32 v5, v6, v7
    v_mul_f32 v8, v8, v224
    v_mul_f32 v9, v9, v224
    v_mul_f32 v10, v10, v224
    v_mfma_f32_16x16x32_bf16 v[132:135], a[92:95], a[44:47], v[132:135]
    ds_write_b64 v233, v[4:5] offset:0
    v_exp_f32 v159, v159
    v_mul_f32 v11, v11, v224
    v_cvt_pk_bf16_f32 v8, v8, v9
    v_cvt_pk_bf16_f32 v9, v10, v11
    v_mfma_f32_16x16x32_bf16 v[136:139], a[96:99], a[32:35], v[168:171]
    v_perm_b32 v151, v159, v158, s27
    v_mul_f32 v12, v12, v224
    v_mul_f32 v13, v13, v224
    v_mul_f32 v14, v14, v224
    v_mul_f32 v15, v15, v224
    v_cvt_pk_bf16_f32 v12, v12, v13
    v_mfma_f32_16x16x32_bf16 v[136:139], a[100:103], a[36:39], v[136:139]
    ds_write_b64 v234, v[8:9] offset:0
    v_cvt_pk_bf16_f32 v13, v14, v15
    v_mul_f32 v16, v16, v224
    v_mul_f32 v17, v17, v224
    v_mul_f32 v18, v18, v224
    v_mul_f32 v19, v19, v224
    v_mfma_f32_16x16x32_bf16 v[136:139], a[104:107], a[40:43], v[136:139]
    ds_write_b64 v235, v[12:13] offset:0
    v_exp_f32 v128, v128
    v_cvt_pk_bf16_f32 v16, v16, v17
    v_cvt_pk_bf16_f32 v17, v18, v19
    v_mul_f32 v20, v20, v224
    v_mfma_f32_16x16x32_bf16 v[136:139], a[108:111], a[44:47], v[136:139]
    ds_write_b64 v236, v[16:17] offset:0
    v_mul_f32 v21, v21, v224
    v_mul_f32 v22, v22, v224
    v_mul_f32 v23, v23, v224
    v_cvt_pk_bf16_f32 v20, v20, v21
    v_cvt_pk_bf16_f32 v21, v22, v23
    v_mfma_f32_16x16x32_bf16 v[140:143], a[112:115], a[32:35], v[168:171]
    v_exp_f32 v129, v129
    v_mul_f32 v24, v24, v224
    v_mul_f32 v25, v25, v224
    v_mul_f32 v26, v26, v224
    v_mul_f32 v27, v27, v224
    v_mfma_f32_16x16x32_bf16 v[140:143], a[116:119], a[36:39], v[140:143]
    ds_write_b64 v237, v[20:21] offset:0
    v_perm_b32 v128, v129, v128, s27
    v_cvt_pk_bf16_f32 v24, v24, v25
    v_cvt_pk_bf16_f32 v25, v26, v27
    v_mul_f32 v28, v28, v224
    v_mul_f32 v29, v29, v224
    v_mfma_f32_16x16x32_bf16 v[140:143], a[120:123], a[40:43], v[140:143]
    v_exp_f32 v130, v130
    v_mul_f32 v30, v30, v224
    v_mul_f32 v31, v31, v224
    v_cvt_pk_bf16_f32 v28, v28, v29
    v_cvt_pk_bf16_f32 v29, v30, v31
    v_mfma_f32_16x16x32_bf16 v[140:143], a[124:127], a[44:47], v[140:143]
    ds_write_b64 v238, v[24:25] offset:0
    ds_write_b64 v239, v[28:29] offset:0
    ds_read_b128 v[0:3], v216 offset:0
    ds_read_b128 v[4:7], v240 offset:1024
    ds_read_b128 v[8:11], v216 offset:2048
    ds_read_b128 v[12:15], v240 offset:3072
    v_smfmac_f32_16x16x64_bf16 v[180:183], v[204:207], v[144:151], v220
    v_exp_f32 v131, v131
    v_mfma_f32_16x16x32_bf16 v[32:35], a[192:195], v[144:147], v[32:35]
    v_perm_b32 v129, v131, v130, s27
    v_mfma_f32_16x16x32_bf16 v[32:35], a[196:199], v[148:151], v[32:35]
    v_exp_f32 v132, v132
    v_mfma_f32_16x16x32_bf16 v[36:39], a[200:203], v[144:147], v[36:39]
    v_mfma_f32_16x16x32_bf16 v[36:39], a[204:207], v[148:151], v[36:39]
    v_exp_f32 v133, v133
    v_mfma_f32_16x16x32_bf16 v[40:43], a[208:211], v[144:147], v[40:43]
    v_perm_b32 v130, v133, v132, s27
    s_waitcnt lgkmcnt(0)
    buffer_store_dwordx4 v[0:3], v217, s[16:19], s42 offen offset:0 sc0 sc1
    buffer_store_dwordx4 v[4:7], v217, s[16:19], s42 offen offset:1024 sc0 sc1
    buffer_store_dwordx4 v[8:11], v217, s[16:19], s42 offen offset:2048 sc0 sc1
    buffer_store_dwordx4 v[12:15], v217, s[16:19], s42 offen offset:3072 sc0 sc1
    s_add_u32 s42, s42, 8192
    v_mfma_f32_16x16x32_bf16 v[40:43], a[212:215], v[148:151], v[40:43]
    v_exp_f32 v134, v134
    v_mfma_f32_16x16x32_bf16 v[44:47], a[216:219], v[144:147], v[44:47]
    v_mfma_f32_16x16x32_bf16 v[44:47], a[220:223], v[148:151], v[44:47]
    v_exp_f32 v135, v135
    v_mfma_f32_16x16x32_bf16 v[48:51], a[224:227], v[144:147], v[48:51]
    v_perm_b32 v131, v135, v134, s27
    v_mfma_f32_16x16x32_bf16 v[48:51], a[228:231], v[148:151], v[48:51]
    v_exp_f32 v136, v136
    v_mfma_f32_16x16x32_bf16 v[52:55], a[232:235], v[144:147], v[52:55]
    v_mfma_f32_16x16x32_bf16 v[52:55], a[236:239], v[148:151], v[52:55]
    v_exp_f32 v137, v137
    v_mfma_f32_16x16x32_bf16 v[56:59], a[240:243], v[144:147], v[56:59]
    v_perm_b32 v132, v137, v136, s27
    v_mfma_f32_16x16x32_bf16 v[56:59], a[244:247], v[148:151], v[56:59]
    v_exp_f32 v138, v138
    v_mfma_f32_16x16x32_bf16 v[60:63], a[248:251], v[144:147], v[60:63]
    v_mfma_f32_16x16x32_bf16 v[60:63], a[252:255], v[148:151], v[60:63]
    v_exp_f32 v139, v139
    v_mfma_f32_16x16x32_bf16 v[144:147], a[64:67], a[48:51], v[172:175]
    v_perm_b32 v133, v139, v138, s27
    v_mfma_f32_16x16x32_bf16 v[144:147], a[68:71], a[52:55], v[144:147]
    v_exp_f32 v140, v140
    v_mfma_f32_16x16x32_bf16 v[144:147], a[72:75], a[56:59], v[144:147]
    v_mfma_f32_16x16x32_bf16 v[144:147], a[76:79], a[60:63], v[144:147]
    v_exp_f32 v141, v141
    v_add_f32 v180, v180, v181
    v_rcp_f32 v226, v180
    s_nop 0
    v_mul_f32 v32, v32, v226
    v_mfma_f32_16x16x32_bf16 v[148:151], a[80:83], a[48:51], v[172:175]
    v_perm_b32 v134, v141, v140, s27
    v_mul_f32 v33, v33, v226
    v_mul_f32 v34, v34, v226
    v_mul_f32 v35, v35, v226
    v_cvt_pk_bf16_f32 v32, v32, v33
    v_cvt_pk_bf16_f32 v33, v34, v35
    v_mfma_f32_16x16x32_bf16 v[148:151], a[84:87], a[52:55], v[148:151]
    v_exp_f32 v142, v142
    v_mul_f32 v36, v36, v226
    v_mul_f32 v37, v37, v226
    v_mul_f32 v38, v38, v226
    v_mul_f32 v39, v39, v226
    v_mfma_f32_16x16x32_bf16 v[148:151], a[88:91], a[56:59], v[148:151]
    ds_write_b64 v232, v[32:33] offset:4096
    v_cvt_pk_bf16_f32 v36, v36, v37
    v_cvt_pk_bf16_f32 v37, v38, v39
    v_mul_f32 v40, v40, v226
    v_mul_f32 v41, v41, v226
    v_mul_f32 v42, v42, v226
    v_mfma_f32_16x16x32_bf16 v[148:151], a[92:95], a[60:63], v[148:151]
    ds_write_b64 v233, v[36:37] offset:4096
    v_exp_f32 v143, v143
    v_mul_f32 v43, v43, v226
    v_cvt_pk_bf16_f32 v40, v40, v41
    v_cvt_pk_bf16_f32 v41, v42, v43
    v_mfma_f32_16x16x32_bf16 v[152:155], a[96:99], a[48:51], v[172:175]
    v_perm_b32 v135, v143, v142, s27
    v_exp_f32 v144, v144
    v_mul_f32 v44, v44, v226
    v_mul_f32 v45, v45, v226
    v_mul_f32 v46, v46, v226
    v_mfma_f32_16x16x32_bf16 v[152:155], a[100:103], a[52:55], v[152:155]
    ds_write_b64 v234, v[40:41] offset:4096
    v_exp_f32 v145, v145
    v_mul_f32 v47, v47, v226
    v_cvt_pk_bf16_f32 v44, v44, v45
    v_cvt_pk_bf16_f32 v45, v46, v47
    v_mfma_f32_16x16x32_bf16 v[152:155], a[104:107], a[56:59], v[152:155]
    v_perm_b32 v144, v145, v144, s27
    v_mul_f32 v48, v48, v226
    v_mul_f32 v49, v49, v226
    v_mul_f32 v50, v50, v226
    v_mul_f32 v51, v51, v226
    v_cvt_pk_bf16_f32 v48, v48, v49
    v_mfma_f32_16x16x32_bf16 v[152:155], a[108:111], a[60:63], v[152:155]
    ds_write_b64 v235, v[44:45] offset:4096
    v_exp_f32 v146, v146
    v_cvt_pk_bf16_f32 v49, v50, v51
    v_mul_f32 v52, v52, v226
    v_mul_f32 v53, v53, v226
    v_mfma_f32_16x16x32_bf16 v[156:159], a[112:115], a[48:51], v[172:175]
    v_exp_f32 v147, v147
    v_mul_f32 v54, v54, v226
    v_mul_f32 v55, v55, v226
    v_cvt_pk_bf16_f32 v52, v52, v53
    v_cvt_pk_bf16_f32 v53, v54, v55
    v_mfma_f32_16x16x32_bf16 v[156:159], a[116:119], a[52:55], v[156:159]
    ds_write_b64 v236, v[48:49] offset:4096
    v_perm_b32 v145, v147, v146, s27
    v_mul_f32 v56, v56, v226
    v_mul_f32 v57, v57, v226
    v_mul_f32 v58, v58, v226
    v_mul_f32 v59, v59, v226
    v_mfma_f32_16x16x32_bf16 v[156:159], a[120:123], a[56:59], v[156:159]
    ds_write_b64 v237, v[52:53] offset:4096
    v_exp_f32 v148, v148
    v_cvt_pk_bf16_f32 v56, v56, v57
    v_cvt_pk_bf16_f32 v57, v58, v59
    v_mul_f32 v60, v60, v226
    v_mfma_f32_16x16x32_bf16 v[156:159], a[124:127], a[60:63], v[156:159]
    v_exp_f32 v149, v149
    v_mul_f32 v61, v61, v226
    v_mul_f32 v62, v62, v226
    v_mul_f32 v63, v63, v226
    v_cvt_pk_bf16_f32 v60, v60, v61
    v_smfmac_f32_16x16x64_bf16 v[184:187], v[204:207], v[128:135], v220
    ds_write_b64 v238, v[56:57] offset:4096
    v_perm_b32 v146, v149, v148, s27
    v_cvt_pk_bf16_f32 v61, v62, v63
    ds_write_b64 v239, v[60:61] offset:4096
    ds_read_b128 v[32:35], v216 offset:4096
    ds_read_b128 v[36:39], v240 offset:5120
    v_mfma_f32_16x16x32_bf16 v[64:67], a[192:195], v[128:131], v[64:67]
    ds_read_b128 v[40:43], v216 offset:6144
    ds_read_b128 v[44:47], v240 offset:7168
    v_exp_f32 v150, v150
    v_mfma_f32_16x16x32_bf16 v[64:67], a[196:199], v[132:135], v[64:67]
    v_exp_f32 v151, v151
    v_mfma_f32_16x16x32_bf16 v[68:71], a[200:203], v[128:131], v[68:71]
    v_perm_b32 v147, v151, v150, s27
    v_mfma_f32_16x16x32_bf16 v[68:71], a[204:207], v[132:135], v[68:71]
    v_exp_f32 v152, v152
    v_mfma_f32_16x16x32_bf16 v[72:75], a[208:211], v[128:131], v[72:75]
    v_exp_f32 v153, v153
    v_mfma_f32_16x16x32_bf16 v[72:75], a[212:215], v[132:135], v[72:75]
    v_perm_b32 v148, v153, v152, s27
    s_waitcnt lgkmcnt(2)
    buffer_store_dwordx4 v[32:35], v217, s[16:19], s43 offen offset:0 sc0 sc1
    buffer_store_dwordx4 v[36:39], v217, s[16:19], s43 offen offset:1024 sc0 sc1
    s_waitcnt lgkmcnt(1)
    buffer_store_dwordx4 v[40:43], v217, s[16:19], s43 offen offset:2048 sc0 sc1
    s_waitcnt lgkmcnt(0)
    buffer_store_dwordx4 v[44:47], v217, s[16:19], s43 offen offset:3072 sc0 sc1
    s_add_u32 s43, s43, 8192
    v_mfma_f32_16x16x32_bf16 v[76:79], a[216:219], v[128:131], v[76:79]
    v_exp_f32 v154, v154
    v_mfma_f32_16x16x32_bf16 v[76:79], a[220:223], v[132:135], v[76:79]
    v_exp_f32 v155, v155
    v_mfma_f32_16x16x32_bf16 v[80:83], a[224:227], v[128:131], v[80:83]
    v_perm_b32 v149, v155, v154, s27
    v_mfma_f32_16x16x32_bf16 v[80:83], a[228:231], v[132:135], v[80:83]
    v_exp_f32 v156, v156
    v_mfma_f32_16x16x32_bf16 v[84:87], a[232:235], v[128:131], v[84:87]
    v_exp_f32 v157, v157
    v_mfma_f32_16x16x32_bf16 v[84:87], a[236:239], v[132:135], v[84:87]
    v_perm_b32 v150, v157, v156, s27
    v_mfma_f32_16x16x32_bf16 v[88:91], a[240:243], v[128:131], v[88:91]
    v_exp_f32 v158, v158
    v_mfma_f32_16x16x32_bf16 v[88:91], a[244:247], v[132:135], v[88:91]
    v_exp_f32 v159, v159
    v_mfma_f32_16x16x32_bf16 v[92:95], a[248:251], v[128:131], v[92:95]
    v_perm_b32 v151, v159, v158, s27
    v_mfma_f32_16x16x32_bf16 v[92:95], a[252:255], v[132:135], v[92:95]
    s_nop 0
    v_smfmac_f32_16x16x64_bf16 v[188:191], v[204:207], v[144:151], v220
    v_mfma_f32_16x16x32_bf16 v[96:99], a[192:195], v[144:147], v[96:99]
    v_mfma_f32_16x16x32_bf16 v[96:99], a[196:199], v[148:151], v[96:99]
    v_add_f32 v184, v184, v185
    v_rcp_f32 v228, v184
    s_nop 0
    v_mul_f32 v64, v64, v228
    v_mul_f32 v65, v65, v228
    v_mul_f32 v66, v66, v228
    v_mfma_f32_16x16x32_bf16 v[100:103], a[200:203], v[144:147], v[100:103]
    v_mul_f32 v67, v67, v228
    v_cvt_pk_bf16_f32 v64, v64, v65
    v_cvt_pk_bf16_f32 v65, v66, v67
    v_mul_f32 v68, v68, v228
    v_mul_f32 v69, v69, v228
    v_mul_f32 v70, v70, v228
    v_mfma_f32_16x16x32_bf16 v[100:103], a[204:207], v[148:151], v[100:103]
    ds_write_b64 v232, v[64:65] offset:0
    v_mul_f32 v71, v71, v228
    v_cvt_pk_bf16_f32 v68, v68, v69
    v_cvt_pk_bf16_f32 v69, v70, v71
    v_mul_f32 v72, v72, v228
    v_mul_f32 v73, v73, v228
    v_mfma_f32_16x16x32_bf16 v[104:107], a[208:211], v[144:147], v[104:107]
    ds_write_b64 v233, v[68:69] offset:0
    v_mul_f32 v74, v74, v228
    v_mul_f32 v75, v75, v228
    v_cvt_pk_bf16_f32 v72, v72, v73
    v_cvt_pk_bf16_f32 v73, v74, v75
    v_mul_f32 v76, v76, v228
    v_mfma_f32_16x16x32_bf16 v[104:107], a[212:215], v[148:151], v[104:107]
    ds_write_b64 v234, v[72:73] offset:0
    v_mul_f32 v77, v77, v228
    v_mul_f32 v78, v78, v228
    v_mul_f32 v79, v79, v228
    v_cvt_pk_bf16_f32 v76, v76, v77
    v_cvt_pk_bf16_f32 v77, v78, v79
    v_mfma_f32_16x16x32_bf16 v[108:111], a[216:219], v[144:147], v[108:111]
    v_mul_f32 v80, v80, v228
    v_mul_f32 v81, v81, v228
    v_mul_f32 v82, v82, v228
    v_mul_f32 v83, v83, v228
    v_cvt_pk_bf16_f32 v80, v80, v81
    v_cvt_pk_bf16_f32 v81, v82, v83
    v_mfma_f32_16x16x32_bf16 v[108:111], a[220:223], v[148:151], v[108:111]
    ds_write_b64 v235, v[76:77] offset:0
    v_mul_f32 v84, v84, v228
    v_mul_f32 v85, v85, v228
    v_mul_f32 v86, v86, v228
    v_mul_f32 v87, v87, v228
    v_cvt_pk_bf16_f32 v84, v84, v85
    v_mfma_f32_16x16x32_bf16 v[112:115], a[224:227], v[144:147], v[112:115]
    ds_write_b64 v236, v[80:81] offset:0
    v_cvt_pk_bf16_f32 v85, v86, v87
    v_mul_f32 v88, v88, v228
    v_mul_f32 v89, v89, v228
    v_mul_f32 v90, v90, v228
    v_mul_f32 v91, v91, v228
    v_mfma_f32_16x16x32_bf16 v[112:115], a[228:231], v[148:151], v[112:115]
    ds_write_b64 v237, v[84:85] offset:0
    v_cvt_pk_bf16_f32 v88, v88, v89
    v_cvt_pk_bf16_f32 v89, v90, v91
    v_mul_f32 v92, v92, v228
    v_mul_f32 v93, v93, v228
    v_mul_f32 v94, v94, v228
    v_mfma_f32_16x16x32_bf16 v[116:119], a[232:235], v[144:147], v[116:119]
    ds_write_b64 v238, v[88:89] offset:0
    v_mul_f32 v95, v95, v228
    v_cvt_pk_bf16_f32 v92, v92, v93
    v_cvt_pk_bf16_f32 v93, v94, v95
    ds_write_b64 v239, v[92:93] offset:0
    ds_read_b128 v[64:67], v216 offset:0
    v_mfma_f32_16x16x32_bf16 v[116:119], a[236:239], v[148:151], v[116:119]
    ds_read_b128 v[68:71], v240 offset:1024
    ds_read_b128 v[72:75], v216 offset:2048
    ds_read_b128 v[76:79], v240 offset:3072
    v_mfma_f32_16x16x32_bf16 v[120:123], a[240:243], v[144:147], v[120:123]
    v_mfma_f32_16x16x32_bf16 v[120:123], a[244:247], v[148:151], v[120:123]
    v_mfma_f32_16x16x32_bf16 v[124:127], a[248:251], v[144:147], v[124:127]
    v_mfma_f32_16x16x32_bf16 v[124:127], a[252:255], v[148:151], v[124:127]
    v_mov_b32 v245, 0x5d800000
    v_add_f32 v188, v188, v189
    v_rcp_f32 v230, v188
    v_add_f32 v244, v176, v180
    v_add_f32 v244, v244, v184
    v_add_f32 v244, v244, v188
    v_cmp_nlt_f32 vcc, v244, v245
    v_pk_mul_f32 v[96:97], v[96:97], v[230:231] op_sel_hi:[1,0]
    v_pk_mul_f32 v[98:99], v[98:99], v[230:231] op_sel_hi:[1,0]
    v_cvt_pk_bf16_f32 v96, v96, v97
    v_cvt_pk_bf16_f32 v97, v98, v99
    v_pk_mul_f32 v[100:101], v[100:101], v[230:231] op_sel_hi:[1,0]
    v_pk_mul_f32 v[102:103], v[102:103], v[230:231] op_sel_hi:[1,0]
    v_cvt_pk_bf16_f32 v100, v100, v101
    v_cvt_pk_bf16_f32 v101, v102, v103
    s_waitcnt lgkmcnt(0)
    buffer_store_dwordx4 v[64:67], v217, s[16:19], s42 offen offset:0 sc0 sc1
    buffer_store_dwordx4 v[68:71], v217, s[16:19], s42 offen offset:1024 sc0 sc1
    buffer_store_dwordx4 v[72:75], v217, s[16:19], s42 offen offset:2048 sc0 sc1
    buffer_store_dwordx4 v[76:79], v217, s[16:19], s42 offen offset:3072 sc0 sc1
    s_add_u32 s42, s42, 8192
    ds_write_b64 v232, v[96:97] offset:4096
    v_pk_mul_f32 v[104:105], v[104:105], v[230:231] op_sel_hi:[1,0]
    v_pk_mul_f32 v[106:107], v[106:107], v[230:231] op_sel_hi:[1,0]
    v_cvt_pk_bf16_f32 v104, v104, v105
    v_cvt_pk_bf16_f32 v105, v106, v107
    ds_write_b64 v233, v[100:101] offset:4096
    v_pk_mul_f32 v[108:109], v[108:109], v[230:231] op_sel_hi:[1,0]
    v_pk_mul_f32 v[110:111], v[110:111], v[230:231] op_sel_hi:[1,0]
    v_cvt_pk_bf16_f32 v108, v108, v109
    v_cvt_pk_bf16_f32 v109, v110, v111
    ds_write_b64 v234, v[104:105] offset:4096
    v_pk_mul_f32 v[112:113], v[112:113], v[230:231] op_sel_hi:[1,0]
    v_pk_mul_f32 v[114:115], v[114:115], v[230:231] op_sel_hi:[1,0]
    v_cvt_pk_bf16_f32 v112, v112, v113
    v_cvt_pk_bf16_f32 v113, v114, v115
    ds_write_b64 v235, v[108:109] offset:4096
    v_pk_mul_f32 v[116:117], v[116:117], v[230:231] op_sel_hi:[1,0]
    v_pk_mul_f32 v[118:119], v[118:119], v[230:231] op_sel_hi:[1,0]
    v_cvt_pk_bf16_f32 v116, v116, v117
    v_cvt_pk_bf16_f32 v117, v118, v119
    ds_write_b64 v236, v[112:113] offset:4096
    v_pk_mul_f32 v[120:121], v[120:121], v[230:231] op_sel_hi:[1,0]
    v_pk_mul_f32 v[122:123], v[122:123], v[230:231] op_sel_hi:[1,0]
    v_cvt_pk_bf16_f32 v120, v120, v121
    v_cvt_pk_bf16_f32 v121, v122, v123
    ds_write_b64 v237, v[116:117] offset:4096
    v_pk_mul_f32 v[124:125], v[124:125], v[230:231] op_sel_hi:[1,0]
    v_pk_mul_f32 v[126:127], v[126:127], v[230:231] op_sel_hi:[1,0]
    v_cvt_pk_bf16_f32 v124, v124, v125
    v_cvt_pk_bf16_f32 v125, v126, v127
    ds_write_b64 v238, v[120:121] offset:4096
    ds_write_b64 v239, v[124:125] offset:4096
    ds_read_b128 v[96:99], v216 offset:4096
    ds_read_b128 v[100:103], v240 offset:5120
    ds_read_b128 v[104:107], v216 offset:6144
    ds_read_b128 v[108:111], v240 offset:7168
    s_waitcnt lgkmcnt(0)
    buffer_store_dwordx4 v[96:99], v217, s[16:19], s43 offen offset:0 sc0 sc1
    buffer_store_dwordx4 v[100:103], v217, s[16:19], s43 offen offset:1024 sc0 sc1
    buffer_store_dwordx4 v[104:107], v217, s[16:19], s43 offen offset:2048 sc0 sc1
    buffer_store_dwordx4 v[108:111], v217, s[16:19], s43 offen offset:3072 sc0 sc1
    s_cbranch_vccnz L_slow
    s_branch L_done
L_tailB:
    v_mfma_f32_16x16x32_bf16 v[144:147], a[64:67], a[16:19], v[164:167]
    ds_read_b64_tr_b16 a[244:245], v202 offset:57344
    v_perm_b32 v133, v139, v138, s27
    v_mfma_f32_16x16x32_bf16 v[144:147], a[68:71], a[20:23], v[144:147]
    v_exp_f32 v140, v140
    v_mfma_f32_16x16x32_bf16 v[144:147], a[72:75], a[24:27], v[144:147]
    ds_read_b64_tr_b16 a[246:247], v202 offset:61440
    ds_read_b64_tr_b16 a[248:249], v203 offset:49152
    v_mfma_f32_16x16x32_bf16 v[144:147], a[76:79], a[28:31], v[144:147]
    v_exp_f32 v141, v141
    v_mfma_f32_16x16x32_bf16 v[148:151], a[80:83], a[16:19], v[164:167]
    ds_read_b64_tr_b16 a[250:251], v203 offset:53248
    v_perm_b32 v134, v141, v140, s27
    v_mfma_f32_16x16x32_bf16 v[148:151], a[84:87], a[20:23], v[148:151]
    v_exp_f32 v142, v142
    v_mfma_f32_16x16x32_bf16 v[148:151], a[88:91], a[24:27], v[148:151]
    ds_read_b64_tr_b16 a[252:253], v203 offset:57344
    ds_read_b64_tr_b16 a[254:255], v203 offset:61440
    v_mfma_f32_16x16x32_bf16 v[148:151], a[92:95], a[28:31], v[148:151]
    v_exp_f32 v143, v143
    v_mfma_f32_16x16x32_bf16 v[152:155], a[96:99], a[16:19], v[164:167]
    v_perm_b32 v135, v143, v142, s27
    s_lshl_b32 s42, s20, 14
    v_mfma_f32_16x16x32_bf16 v[152:155], a[100:103], a[20:23], v[152:155]
    s_add_u32 s43, s42, 4096
    v_mfma_f32_16x16x32_bf16 v[152:155], a[104:107], a[24:27], v[152:155]
    v_exp_f32 v144, v144
    v_mfma_f32_16x16x32_bf16 v[152:155], a[108:111], a[28:31], v[152:155]
    v_mfma_f32_16x16x32_bf16 v[156:159], a[112:115], a[16:19], v[164:167]
    v_exp_f32 v145, v145
    v_mfma_f32_16x16x32_bf16 v[156:159], a[116:119], a[20:23], v[156:159]
    v_perm_b32 v144, v145, v144, s27
    v_mfma_f32_16x16x32_bf16 v[156:159], a[120:123], a[24:27], v[156:159]
    v_exp_f32 v146, v146
    v_mfma_f32_16x16x32_bf16 v[156:159], a[124:127], a[28:31], v[156:159]
    v_smfmac_f32_16x16x64_bf16 v[176:179], v[204:207], v[128:135], v220
    v_exp_f32 v147, v147
    v_mfma_f32_16x16x32_bf16 v[0:3], a[192:195], v[128:131], v[0:3]
    v_perm_b32 v145, v147, v146, s27
    s_waitcnt lgkmcnt(0)
    v_mfma_f32_16x16x32_bf16 v[0:3], a[196:199], v[132:135], v[0:3]
    v_exp_f32 v148, v148
    v_mfma_f32_16x16x32_bf16 v[4:7], a[200:203], v[128:131], v[4:7]
    v_mfma_f32_16x16x32_bf16 v[4:7], a[204:207], v[132:135], v[4:7]
    v_exp_f32 v149, v149
    v_mfma_f32_16x16x32_bf16 v[8:11], a[208:211], v[128:131], v[8:11]
    v_perm_b32 v146, v149, v148, s27
    v_mfma_f32_16x16x32_bf16 v[8:11], a[212:215], v[132:135], v[8:11]
    v_exp_f32 v150, v150
    v_mfma_f32_16x16x32_bf16 v[12:15], a[216:219], v[128:131], v[12:15]
    v_mfma_f32_16x16x32_bf16 v[12:15], a[220:223], v[132:135], v[12:15]
    v_exp_f32 v151, v151
    v_mfma_f32_16x16x32_bf16 v[16:19], a[224:227], v[128:131], v[16:19]
    v_perm_b32 v147, v151, v150, s27
    v_mfma_f32_16x16x32_bf16 v[16:19], a[228:231], v[132:135], v[16:19]
    v_exp_f32 v152, v152
    v_mfma_f32_16x16x32_bf16 v[20:23], a[232:235], v[128:131], v[20:23]
    v_mfma_f32_16x16x32_bf16 v[20:23], a[236:239], v[132:135], v[20:23]
    v_exp_f32 v153, v153
    v_mfma_f32_16x16x32_bf16 v[24:27], a[240:243], v[128:131], v[24:27]
    v_perm_b32 v148, v153, v152, s27
    v_mfma_f32_16x16x32_bf16 v[24:27], a[244:247], v[132:135], v[24:27]
    v_exp_f32 v154, v154
    v_mfma_f32_16x16x32_bf16 v[28:31], a[248:251], v[128:131], v[28:31]
    v_mfma_f32_16x16x32_bf16 v[28:31], a[252:255], v[132:135], v[28:31]
    v_exp_f32 v155, v155
    v_mfma_f32_16x16x32_bf16 v[128:131], a[64:67], a[32:35], v[168:171]
    v_perm_b32 v149, v155, v154, s27
    v_mfma_f32_16x16x32_bf16 v[128:131], a[68:71], a[36:39], v[128:131]
    v_exp_f32 v156, v156
    v_mfma_f32_16x16x32_bf16 v[128:131], a[72:75], a[40:43], v[128:131]
    v_mfma_f32_16x16x32_bf16 v[128:131], a[76:79], a[44:47], v[128:131]
    v_exp_f32 v157, v157
    v_add_f32 v176, v176, v177
    v_rcp_f32 v224, v176
    s_nop 0
    v_mul_f32 v0, v0, v224
    v_mfma_f32_16x16x32_bf16 v[132:135], a[80:83], a[32:35], v[168:171]
    v_perm_b32 v150, v157, v156, s27
    v_mul_f32 v1, v1, v224
    v_mul_f32 v2, v2, v224
    v_mul_f32 v3, v3, v224
    v_cvt_pk_bf16_f32 v0, v0, v1
    v_cvt_pk_bf16_f32 v1, v2, v3
    v_mfma_f32_16x16x32_bf16 v[132:135], a[84:87], a[36:39], v[132:135]
    v_exp_f32 v158, v158
    v_mul_f32 v4, v4, v224
    v_mul_f32 v5, v5, v224
    v_mul_f32 v6, v6, v224
    v_mul_f32 v7, v7, v224
    v_mfma_f32_16x16x32_bf16 v[132:135], a[88:91], a[40:43], v[132:135]
    ds_write_b64 v232, v[0:1] offset:0
    v_cvt_pk_bf16_f32 v4, v4, v5
    v_cvt_pk_bf16_f32 v5, v6, v7
    v_mul_f32 v8, v8, v224
    v_mul_f32 v9, v9, v224
    v_mul_f32 v10, v10, v224
    v_mfma_f32_16x16x32_bf16 v[132:135], a[92:95], a[44:47], v[132:135]
    ds_write_b64 v233, v[4:5] offset:0
    v_exp_f32 v159, v159
    v_mul_f32 v11, v11, v224
    v_cvt_pk_bf16_f32 v8, v8, v9
    v_cvt_pk_bf16_f32 v9, v10, v11
    v_mfma_f32_16x16x32_bf16 v[136:139], a[96:99], a[32:35], v[168:171]
    v_perm_b32 v151, v159, v158, s27
    v_exp_f32 v128, v128
    v_mul_f32 v12, v12, v224
    v_mul_f32 v13, v13, v224
    v_mul_f32 v14, v14, v224
    v_mfma_f32_16x16x32_bf16 v[136:139], a[100:103], a[36:39], v[136:139]
    ds_write_b64 v234, v[8:9] offset:0
    v_exp_f32 v129, v129
    v_mul_f32 v15, v15, v224
    v_cvt_pk_bf16_f32 v12, v12, v13
    v_cvt_pk_bf16_f32 v13, v14, v15
    v_mfma_f32_16x16x32_bf16 v[136:139], a[104:107], a[40:43], v[136:139]
    v_perm_b32 v128, v129, v128, s27
    v_mul_f32 v16, v16, v224
    v_mul_f32 v17, v17, v224
    v_mul_f32 v18, v18, v224
    v_mul_f32 v19, v19, v224
    v_cvt_pk_bf16_f32 v16, v16, v17
    v_mfma_f32_16x16x32_bf16 v[136:139], a[108:111], a[44:47], v[136:139]
    ds_write_b64 v235, v[12:13] offset:0
    v_exp_f32 v130, v130
    v_cvt_pk_bf16_f32 v17, v18, v19
    v_mul_f32 v20, v20, v224
    v_mul_f32 v21, v21, v224
    v_mfma_f32_16x16x32_bf16 v[140:143], a[112:115], a[32:35], v[168:171]
    v_exp_f32 v131, v131
    v_mul_f32 v22, v22, v224
    v_mul_f32 v23, v23, v224
    v_cvt_pk_bf16_f32 v20, v20, v21
    v_cvt_pk_bf16_f32 v21, v22, v23
    v_mfma_f32_16x16x32_bf16 v[140:143], a[116:119], a[36:39], v[140:143]
    ds_write_b64 v236, v[16:17] offset:0
    v_perm_b32 v129, v131, v130, s27
    v_mul_f32 v24, v24, v224
    v_mul_f32 v25, v25, v224
    v_mul_f32 v26, v26, v224
    v_mul_f32 v27, v27, v224
    v_mfma_f32_16x16x32_bf16 v[140:143], a[120:123], a[40:43], v[140:143]
    ds_write_b64 v237, v[20:21] offset:0
    v_exp_f32 v132, v132
    v_cvt_pk_bf16_f32 v24, v24, v25
    v_cvt_pk_bf16_f32 v25, v26, v27
    v_mul_f32 v28, v28, v224
    v_mfma_f32_16x16x32_bf16 v[140:143], a[124:127], a[44:47], v[140:143]
    v_exp_f32 v133, v133
    v_mul_f32 v29, v29, v224
    v_mul_f32 v30, v30, v224
    v_mul_f32 v31, v31, v224
    v_cvt_pk_bf16_f32 v28, v28, v29
    v_smfmac_f32_16x16x64_bf16 v[180:183], v[204:207], v[144:151], v220
    ds_write_b64 v238, v[24:25] offset:0
    v_perm_b32 v130, v133, v132, s27
    v_cvt_pk_bf16_f32 v29, v30, v31
    ds_write_b64 v239, v[28:29] offset:0
    ds_read_b128 v[0:3], v216 offset:0
    ds_read_b128 v[4:7], v240 offset:1024
    v_mfma_f32_16x16x32_bf16 v[32:35], a[192:195], v[144:147], v[32:35]
    ds_read_b128 v[8:11], v216 offset:2048
    ds_read_b128 v[12:15], v240 offset:3072
    v_exp_f32 v134, v134
    v_mfma_f32_16x16x32_bf16 v[32:35], a[196:199], v[148:151], v[32:35]
    v_exp_f32 v135, v135
    v_mfma_f32_16x16x32_bf16 v[36:39], a[200:203], v[144:147], v[36:39]
    v_perm_b32 v131, v135, v134, s27
    v_mfma_f32_16x16x32_bf16 v[36:39], a[204:207], v[148:151], v[36:39]
    v_exp_f32 v136, v136
    v_mfma_f32_16x16x32_bf16 v[40:43], a[208:211], v[144:147], v[40:43]
    v_exp_f32 v137, v137
    v_mfma_f32_16x16x32_bf16 v[40:43], a[212:215], v[148:151], v[40:43]
    v_perm_b32 v132, v137, v136, s27
    s_waitcnt lgkmcnt(2)
    buffer_store_dwordx4 v[0:3], v217, s[16:19], s42 offen offset:0 sc0 sc1
    buffer_store_dwordx4 v[4:7], v217, s[16:19], s42 offen offset:1024 sc0 sc1
    s_waitcnt lgkmcnt(1)
    buffer_store_dwordx4 v[8:11], v217, s[16:19], s42 offen offset:2048 sc0 sc1
    s_waitcnt lgkmcnt(0)
    buffer_store_dwordx4 v[12:15], v217, s[16:19], s42 offen offset:3072 sc0 sc1
    s_add_u32 s42, s42, 8192
    v_mfma_f32_16x16x32_bf16 v[44:47], a[216:219], v[144:147], v[44:47]
    v_exp_f32 v138, v138
    v_mfma_f32_16x16x32_bf16 v[44:47], a[220:223], v[148:151], v[44:47]
    v_exp_f32 v139, v139
    v_mfma_f32_16x16x32_bf16 v[48:51], a[224:227], v[144:147], v[48:51]
    v_perm_b32 v133, v139, v138, s27
    v_mfma_f32_16x16x32_bf16 v[48:51], a[228:231], v[148:151], v[48:51]
    v_exp_f32 v140, v140
    v_mfma_f32_16x16x32_bf16 v[52:55], a[232:235], v[144:147], v[52:55]
    v_exp_f32 v141, v141
    v_mfma_f32_16x16x32_bf16 v[52:55], a[236:239], v[148:151], v[52:55]
    v_perm_b32 v134, v141, v140, s27
    v_mfma_f32_16x16x32_bf16 v[56:59], a[240:243], v[144:147], v[56:59]
    v_exp_f32 v142, v142
    v_mfma_f32_16x16x32_bf16 v[56:59], a[244:247], v[148:151], v[56:59]
    v_exp_f32 v143, v143
    v_mfma_f32_16x16x32_bf16 v[60:63], a[248:251], v[144:147], v[60:63]
    v_perm_b32 v135, v143, v142, s27
    v_mfma_f32_16x16x32_bf16 v[60:63], a[252:255], v[148:151], v[60:63]
    s_nop 0
    v_smfmac_f32_16x16x64_bf16 v[184:187], v[204:207], v[128:135], v220
    v_mfma_f32_16x16x32_bf16 v[64:67], a[192:195], v[128:131], v[64:67]
    v_mfma_f32_16x16x32_bf16 v[64:67], a[196:199], v[132:135], v[64:67]
    v_add_f32 v180, v180, v181
    v_rcp_f32 v226, v180
    s_nop 0
    v_mul_f32 v32, v32, v226
    v_mul_f32 v33, v33, v226
    v_mul_f32 v34, v34, v226
    v_mfma_f32_16x16x32_bf16 v[68:71], a[200:203], v[128:131], v[68:71]
    v_mul_f32 v35, v35, v226
    v_cvt_pk_bf16_f32 v32, v32, v33
    v_cvt_pk_bf16_f32 v33, v34, v35
    v_mul_f32 v36, v36, v226
    v_mul_f32 v37, v37, v226
    v_mul_f32 v38, v38, v226
    v_mfma_f32_16x16x32_bf16 v[68:71], a[204:207], v[132:135], v[68:71]
    ds_write_b64 v232, v[32:33] offset:4096
    v_mul_f32 v39, v39, v226
    v_cvt_pk_bf16_f32 v36, v36, v37
    v_cvt_pk_bf16_f32 v37, v38, v39
    v_mul_f32 v40, v40, v226
    v_mul_f32 v41, v41, v226
    v_mfma_f32_16x16x32_bf16 v[72:75], a[208:211], v[128:131], v[72:75]
    ds_write_b64 v233, v[36:37] offset:4096
    v_mul_f32 v42, v42, v226
    v_mul_f32 v43, v43, v226
    v_cvt_pk_bf16_f32 v40, v40, v41
    v_cvt_pk_bf16_f32 v41, v42, v43
    v_mul_f32 v44, v44, v226
    v_mfma_f32_16x16x32_bf16 v[72:75], a[212:215], v[132:135], v[72:75]
    ds_write_b64 v234, v[40:41] offset:4096
    v_mul_f32 v45, v45, v226
    v_mul_f32 v46, v46, v226
    v_mul_f32 v47, v47, v226
    v_cvt_pk_bf16_f32 v44, v44, v45
    v_cvt_pk_bf16_f32 v45, v46, v47
    v_mfma_f32_16x16x32_bf16 v[76:79], a[216:219], v[128:131], v[76:79]
    v_mul_f32 v48, v48, v226
    v_mul_f32 v49, v49, v226
    v_mul_f32 v50, v50, v226
    v_mul_f32 v51, v51, v226
    v_cvt_pk_bf16_f32 v48, v48, v49
    v_cvt_pk_bf16_f32 v49, v50, v51
    v_mfma_f32_16x16x32_bf16 v[76:79], a[220:223], v[132:135], v[76:79]
    ds_write_b64 v235, v[44:45] offset:4096
    v_mul_f32 v52, v52, v226
    v_mul_f32 v53, v53, v226
    v_mul_f32 v54, v54, v226
    v_mul_f32 v55, v55, v226
    v_cvt_pk_bf16_f32 v52, v52, v53
    v_mfma_f32_16x16x32_bf16 v[80:83], a[224:227], v[128:131], v[80:83]
    ds_write_b64 v236, v[48:49] offset:4096
    v_cvt_pk_bf16_f32 v53, v54, v55
    v_mul_f32 v56, v56, v226
    v_mul_f32 v57, v57, v226
    v_mul_f32 v58, v58, v226
    v_mul_f32 v59, v59, v226
    v_mfma_f32_16x16x32_bf16 v[80:83], a[228:231], v[132:135], v[80:83]
    ds_write_b64 v237, v[52:53] offset:4096
    v_cvt_pk_bf16_f32 v56, v56, v57
    v_cvt_pk_bf16_f32 v57, v58, v59
    v_mul_f32 v60, v60, v226
    v_mul_f32 v61, v61, v226
    v_mul_f32 v62, v62, v226
    v_mfma_f32_16x16x32_bf16 v[84:87], a[232:235], v[128:131], v[84:87]
    ds_write_b64 v238, v[56:57] offset:4096
    v_mul_f32 v63, v63, v226
    v_cvt_pk_bf16_f32 v60, v60, v61
    v_cvt_pk_bf16_f32 v61, v62, v63
    ds_write_b64 v239, v[60:61] offset:4096
    ds_read_b128 v[32:35], v216 offset:4096
    v_mfma_f32_16x16x32_bf16 v[84:87], a[236:239], v[132:135], v[84:87]
    ds_read_b128 v[36:39], v240 offset:5120
    ds_read_b128 v[40:43], v216 offset:6144
    ds_read_b128 v[44:47], v240 offset:7168
    v_mfma_f32_16x16x32_bf16 v[88:91], a[240:243], v[128:131], v[88:91]
    v_mfma_f32_16x16x32_bf16 v[88:91], a[244:247], v[132:135], v[88:91]
    v_mfma_f32_16x16x32_bf16 v[92:95], a[248:251], v[128:131], v[92:95]
    v_mfma_f32_16x16x32_bf16 v[92:95], a[252:255], v[132:135], v[92:95]
    v_mov_b32 v245, 0x5d800000
    v_add_f32 v184, v184, v185
    v_rcp_f32 v228, v184
    v_add_f32 v244, v176, v180
    v_add_f32 v244, v244, v184
    v_cmp_nlt_f32 vcc, v244, v245
    v_pk_mul_f32 v[64:65], v[64:65], v[228:229] op_sel_hi:[1,0]
    v_pk_mul_f32 v[66:67], v[66:67], v[228:229] op_sel_hi:[1,0]
    v_cvt_pk_bf16_f32 v64, v64, v65
    v_cvt_pk_bf16_f32 v65, v66, v67
    v_pk_mul_f32 v[68:69], v[68:69], v[228:229] op_sel_hi:[1,0]
    v_pk_mul_f32 v[70:71], v[70:71], v[228:229] op_sel_hi:[1,0]
    v_cvt_pk_bf16_f32 v68, v68, v69
    v_cvt_pk_bf16_f32 v69, v70, v71
    s_waitcnt lgkmcnt(0)
    buffer_store_dwordx4 v[32:35], v217, s[16:19], s43 offen offset:0 sc0 sc1
    buffer_store_dwordx4 v[36:39], v217, s[16:19], s43 offen offset:1024 sc0 sc1
    buffer_store_dwordx4 v[40:43], v217, s[16:19], s43 offen offset:2048 sc0 sc1
    buffer_store_dwordx4 v[44:47], v217, s[16:19], s43 offen offset:3072 sc0 sc1
    s_add_u32 s43, s43, 8192
    ds_write_b64 v232, v[64:65] offset:0
    v_pk_mul_f32 v[72:73], v[72:73], v[228:229] op_sel_hi:[1,0]
    v_pk_mul_f32 v[74:75], v[74:75], v[228:229] op_sel_hi:[1,0]
    v_cvt_pk_bf16_f32 v72, v72, v73
    v_cvt_pk_bf16_f32 v73, v74, v75
    ds_write_b64 v233, v[68:69] offset:0
    v_pk_mul_f32 v[76:77], v[76:77], v[228:229] op_sel_hi:[1,0]
    v_pk_mul_f32 v[78:79], v[78:79], v[228:229] op_sel_hi:[1,0]
    v_cvt_pk_bf16_f32 v76, v76, v77
    v_cvt_pk_bf16_f32 v77, v78, v79
    ds_write_b64 v234, v[72:73] offset:0
    v_pk_mul_f32 v[80:81], v[80:81], v[228:229] op_sel_hi:[1,0]
    v_pk_mul_f32 v[82:83], v[82:83], v[228:229] op_sel_hi:[1,0]
    v_cvt_pk_bf16_f32 v80, v80, v81
    v_cvt_pk_bf16_f32 v81, v82, v83
    ds_write_b64 v235, v[76:77] offset:0
    v_pk_mul_f32 v[84:85], v[84:85], v[228:229] op_sel_hi:[1,0]
    v_pk_mul_f32 v[86:87], v[86:87], v[228:229] op_sel_hi:[1,0]
    v_cvt_pk_bf16_f32 v84, v84, v85
    v_cvt_pk_bf16_f32 v85, v86, v87
    ds_write_b64 v236, v[80:81] offset:0
    v_pk_mul_f32 v[88:89], v[88:89], v[228:229] op_sel_hi:[1,0]
    v_pk_mul_f32 v[90:91], v[90:91], v[228:229] op_sel_hi:[1,0]
    v_cvt_pk_bf16_f32 v88, v88, v89
    v_cvt_pk_bf16_f32 v89, v90, v91
    ds_write_b64 v237, v[84:85] offset:0
    v_pk_mul_f32 v[92:93], v[92:93], v[228:229] op_sel_hi:[1,0]
    v_pk_mul_f32 v[94:95], v[94:95], v[228:229] op_sel_hi:[1,0]
    v_cvt_pk_bf16_f32 v92, v92, v93
    v_cvt_pk_bf16_f32 v93, v94, v95
    ds_write_b64 v238, v[88:89] offset:0
    ds_write_b64 v239, v[92:93] offset:0
    ds_read_b128 v[64:67], v216 offset:0
    ds_read_b128 v[68:71], v240 offset:1024
    ds_read_b128 v[72:75], v216 offset:2048
    ds_read_b128 v[76:79], v240 offset:3072
    s_waitcnt lgkmcnt(0)
    buffer_store_dwordx4 v[64:67], v217, s[16:19], s42 offen offset:0 sc0 sc1
    buffer_store_dwordx4 v[68:71], v217, s[16:19], s42 offen offset:1024 sc0 sc1
    buffer_store_dwordx4 v[72:75], v217, s[16:19], s42 offen offset:2048 sc0 sc1
    buffer_store_dwordx4 v[76:79], v217, s[16:19], s42 offen offset:3072 sc0 sc1
    s_cbranch_vccnz L_slow
    s_branch L_done
L_loops:
.p2align 6
L_evenA:
    v_mfma_f32_16x16x32_bf16 v[144:147], a[64:67], a[48:51], v[172:175]
    ds_read_b128 a[64:67], v192 offset:32768
    v_perm_b32 v133, v139, v138, s27
    v_mfma_f32_16x16x32_bf16 v[144:147], a[68:71], a[52:55], v[144:147]
    v_exp_f32 v140, v140
    v_mfma_f32_16x16x32_bf16 v[144:147], a[72:75], a[56:59], v[144:147]
    ds_read_b128 a[68:71], v193 offset:32768
    s_add_u32 s26, s26, 1
    v_mfma_f32_16x16x32_bf16 v[144:147], a[76:79], a[60:63], v[144:147]
    v_exp_f32 v141, v141
    v_mfma_f32_16x16x32_bf16 v[148:151], a[80:83], a[48:51], v[172:175]
    ds_read_b128 a[72:75], v194 offset:32768
    v_perm_b32 v134, v141, v140, s27
    v_mfma_f32_16x16x32_bf16 v[148:151], a[84:87], a[52:55], v[148:151]
    v_exp_f32 v142, v142
    v_mfma_f32_16x16x32_bf16 v[148:151], a[88:91], a[56:59], v[148:151]
    ds_read_b128 a[76:79], v195 offset:32768
    v_mfma_f32_16x16x32_bf16 v[148:151], a[92:95], a[60:63], v[148:151]
    v_exp_f32 v143, v143
    v_mfma_f32_16x16x32_bf16 v[152:155], a[96:99], a[48:51], v[172:175]
    ds_read_b128 a[80:83], v192 offset:36864
    v_perm_b32 v135, v143, v142, s27
    v_mfma_f32_16x16x32_bf16 v[152:155], a[100:103], a[52:55], v[152:155]
    ds_read_b64_tr_b16 a[192:193], v196 offset:49152
    ds_read_b64_tr_b16 a[194:195], v196 offset:53248
    v_mfma_f32_16x16x32_bf16 v[152:155], a[104:107], a[56:59], v[152:155]
    v_exp_f32 v144, v144
    v_mfma_f32_16x16x32_bf16 v[152:155], a[108:111], a[60:63], v[152:155]
    ds_read_b128 a[84:87], v193 offset:36864
    v_mfma_f32_16x16x32_bf16 v[156:159], a[112:115], a[48:51], v[172:175]
    v_exp_f32 v145, v145
    v_mfma_f32_16x16x32_bf16 v[156:159], a[116:119], a[52:55], v[156:159]
    ds_read_b128 a[88:91], v194 offset:36864
    v_perm_b32 v144, v145, v144, s27
    v_mfma_f32_16x16x32_bf16 v[156:159], a[120:123], a[56:59], v[156:159]
    v_exp_f32 v146, v146
    v_mfma_f32_16x16x32_bf16 v[156:159], a[124:127], a[60:63], v[156:159]
    ds_read_b128 a[92:95], v195 offset:36864
    v_smfmac_f32_16x16x64_bf16 v[184:187], v[204:207], v[128:135], v220
    v_exp_f32 v147, v147
    v_mfma_f32_16x16x32_bf16 v[64:67], a[128:131], v[128:131], v[64:67]
    ds_read_b128 a[96:99], v192 offset:40960
    v_perm_b32 v145, v147, v146, s27
    v_mfma_f32_16x16x32_bf16 v[64:67], a[132:135], v[132:135], v[64:67]
    v_exp_f32 v148, v148
    v_mfma_f32_16x16x32_bf16 v[68:71], a[136:139], v[128:131], v[68:71]
    ds_read_b128 a[100:103], v193 offset:40960
    v_mfma_f32_16x16x32_bf16 v[68:71], a[140:143], v[132:135], v[68:71]
    v_exp_f32 v149, v149
    v_mfma_f32_16x16x32_bf16 v[72:75], a[144:147], v[128:131], v[72:75]
    ds_read_b128 a[104:107], v194 offset:40960
    v_perm_b32 v146, v149, v148, s27
    v_mfma_f32_16x16x32_bf16 v[72:75], a[148:151], v[132:135], v[72:75]
    v_exp_f32 v150, v150
    v_mfma_f32_16x16x32_bf16 v[76:79], a[152:155], v[128:131], v[76:79]
    ds_read_b128 a[108:111], v195 offset:40960
    v_mfma_f32_16x16x32_bf16 v[76:79], a[156:159], v[132:135], v[76:79]
    v_exp_f32 v151, v151
    v_mfma_f32_16x16x32_bf16 v[80:83], a[160:163], v[128:131], v[80:83]
    ds_read_b128 a[112:115], v192 offset:45056
    v_perm_b32 v147, v151, v150, s27
    v_mfma_f32_16x16x32_bf16 v[80:83], a[164:167], v[132:135], v[80:83]
    v_exp_f32 v152, v152
    v_mfma_f32_16x16x32_bf16 v[84:87], a[168:171], v[128:131], v[84:87]
    ds_read_b128 a[116:119], v193 offset:45056
    v_mfma_f32_16x16x32_bf16 v[84:87], a[172:175], v[132:135], v[84:87]
    v_exp_f32 v153, v153
    v_mfma_f32_16x16x32_bf16 v[88:91], a[176:179], v[128:131], v[88:91]
    ds_read_b128 a[120:123], v194 offset:45056
    v_perm_b32 v148, v153, v152, s27
    v_mfma_f32_16x16x32_bf16 v[88:91], a[180:183], v[132:135], v[88:91]
    v_exp_f32 v154, v154
    v_mfma_f32_16x16x32_bf16 v[92:95], a[184:187], v[128:131], v[92:95]
    ds_read_b128 a[124:127], v195 offset:45056
    s_waitcnt lgkmcnt(3)
    v_mfma_f32_16x16x32_bf16 v[92:95], a[188:191], v[132:135], v[92:95]
    v_exp_f32 v155, v155
    v_mfma_f32_16x16x32_bf16 v[128:131], a[64:67], a[0:3], v[160:163]
    ds_read_b64_tr_b16 a[196:197], v196 offset:57344
    v_perm_b32 v149, v155, v154, s27
    v_mfma_f32_16x16x32_bf16 v[128:131], a[68:71], a[4:7], v[128:131]
    v_exp_f32 v156, v156
    v_mfma_f32_16x16x32_bf16 v[128:131], a[72:75], a[8:11], v[128:131]
    ds_read_b64_tr_b16 a[198:199], v196 offset:61440
    ds_read_b64_tr_b16 a[200:201], v197 offset:49152
    v_mfma_f32_16x16x32_bf16 v[128:131], a[76:79], a[12:15], v[128:131]
    v_exp_f32 v157, v157
    v_mfma_f32_16x16x32_bf16 v[132:135], a[80:83], a[0:3], v[160:163]
    ds_read_b64_tr_b16 a[202:203], v197 offset:53248
    v_perm_b32 v150, v157, v156, s27
    v_mfma_f32_16x16x32_bf16 v[132:135], a[84:87], a[4:7], v[132:135]
    v_exp_f32 v158, v158
    v_mfma_f32_16x16x32_bf16 v[132:135], a[88:91], a[8:11], v[132:135]
    ds_read_b64_tr_b16 a[204:205], v197 offset:57344
    ds_read_b64_tr_b16 a[206:207], v197 offset:61440
    v_mfma_f32_16x16x32_bf16 v[132:135], a[92:95], a[12:15], v[132:135]
    v_exp_f32 v159, v159
    v_mfma_f32_16x16x32_bf16 v[136:139], a[96:99], a[0:3], v[160:163]
    ds_read_b64_tr_b16 a[208:209], v198 offset:49152
    v_perm_b32 v151, v159, v158, s27
    v_mfma_f32_16x16x32_bf16 v[136:139], a[100:103], a[4:7], v[136:139]
    ds_read_b64_tr_b16 a[210:211], v198 offset:53248
    ds_read_b64_tr_b16 a[212:213], v198 offset:57344
    v_mfma_f32_16x16x32_bf16 v[136:139], a[104:107], a[8:11], v[136:139]
    v_exp_f32 v128, v128
    v_mfma_f32_16x16x32_bf16 v[136:139], a[108:111], a[12:15], v[136:139]
    ds_read_b64_tr_b16 a[214:215], v198 offset:61440
    s_waitcnt lgkmcnt(10)
    v_mfma_f32_16x16x32_bf16 v[140:143], a[112:115], a[0:3], v[160:163]
    v_exp_f32 v129, v129
    v_mfma_f32_16x16x32_bf16 v[140:143], a[116:119], a[4:7], v[140:143]
    ds_read_b64_tr_b16 a[216:217], v199 offset:49152
    v_perm_b32 v128, v129, v128, s27
    v_mfma_f32_16x16x32_bf16 v[140:143], a[120:123], a[8:11], v[140:143]
    v_exp_f32 v130, v130
    v_mfma_f32_16x16x32_bf16 v[140:143], a[124:127], a[12:15], v[140:143]
    ds_read_b64_tr_b16 a[218:219], v199 offset:53248
    ds_read_b64_tr_b16 a[220:221], v199 offset:57344
    v_smfmac_f32_16x16x64_bf16 v[188:191], v[204:207], v[144:151], v220
    v_exp_f32 v131, v131
    v_mfma_f32_16x16x32_bf16 v[96:99], a[128:131], v[144:147], v[96:99]
    ds_read_b64_tr_b16 a[222:223], v199 offset:61440
    v_perm_b32 v129, v131, v130, s27
    v_mfma_f32_16x16x32_bf16 v[96:99], a[132:135], v[148:151], v[96:99]
    v_exp_f32 v132, v132
    v_mfma_f32_16x16x32_bf16 v[100:103], a[136:139], v[144:147], v[100:103]
    ds_read_b64_tr_b16 a[224:225], v200 offset:49152
    ds_read_b64_tr_b16 a[226:227], v200 offset:53248
    v_mfma_f32_16x16x32_bf16 v[100:103], a[140:143], v[148:151], v[100:103]
    v_exp_f32 v133, v133
    v_mfma_f32_16x16x32_bf16 v[104:107], a[144:147], v[144:147], v[104:107]
    ds_read_b64_tr_b16 a[228:229], v200 offset:57344
    v_perm_b32 v130, v133, v132, s27
    v_mfma_f32_16x16x32_bf16 v[104:107], a[148:151], v[148:151], v[104:107]
    v_exp_f32 v134, v134
    v_mfma_f32_16x16x32_bf16 v[108:111], a[152:155], v[144:147], v[108:111]
    ds_read_b64_tr_b16 a[230:231], v200 offset:61440
    ds_read_b64_tr_b16 a[232:233], v201 offset:49152
    v_mfma_f32_16x16x32_bf16 v[108:111], a[156:159], v[148:151], v[108:111]
    v_exp_f32 v135, v135
    v_mfma_f32_16x16x32_bf16 v[112:115], a[160:163], v[144:147], v[112:115]
    v_perm_b32 v131, v135, v134, s27
    s_cmp_eq_u32 s26, 16
    v_mfma_f32_16x16x32_bf16 v[112:115], a[164:167], v[148:151], v[112:115]
    v_exp_f32 v136, v136
    v_mfma_f32_16x16x32_bf16 v[116:119], a[168:171], v[144:147], v[116:119]
    ds_read_b64_tr_b16 a[234:235], v201 offset:53248
    ds_read_b64_tr_b16 a[236:237], v201 offset:57344
    v_mfma_f32_16x16x32_bf16 v[116:119], a[172:175], v[148:151], v[116:119]
    v_exp_f32 v137, v137
    v_mfma_f32_16x16x32_bf16 v[120:123], a[176:179], v[144:147], v[120:123]
    ds_read_b64_tr_b16 a[238:239], v201 offset:61440
    v_perm_b32 v132, v137, v136, s27
    v_mfma_f32_16x16x32_bf16 v[120:123], a[180:183], v[148:151], v[120:123]
    v_exp_f32 v138, v138
    v_mfma_f32_16x16x32_bf16 v[124:127], a[184:187], v[144:147], v[124:127]
    ds_read_b64_tr_b16 a[240:241], v202 offset:49152
    ds_read_b64_tr_b16 a[242:243], v202 offset:53248
    v_mfma_f32_16x16x32_bf16 v[124:127], a[188:191], v[148:151], v[124:127]
    v_exp_f32 v139, v139
    s_cbranch_scc1 L_tailA
L_entryA:
    v_mfma_f32_16x16x32_bf16 v[144:147], a[64:67], a[16:19], v[164:167]
    ds_read_b64_tr_b16 a[244:245], v202 offset:57344
    v_perm_b32 v133, v139, v138, s27
    v_mfma_f32_16x16x32_bf16 v[144:147], a[68:71], a[20:23], v[144:147]
    v_exp_f32 v140, v140
    v_mfma_f32_16x16x32_bf16 v[144:147], a[72:75], a[24:27], v[144:147]
    ds_read_b64_tr_b16 a[246:247], v202 offset:61440
    ds_read_b64_tr_b16 a[248:249], v203 offset:49152
    v_mfma_f32_16x16x32_bf16 v[144:147], a[76:79], a[28:31], v[144:147]
    v_exp_f32 v141, v141
    v_mfma_f32_16x16x32_bf16 v[148:151], a[80:83], a[16:19], v[164:167]
    ds_read_b64_tr_b16 a[250:251], v203 offset:53248
    v_perm_b32 v134, v141, v140, s27
    v_mfma_f32_16x16x32_bf16 v[148:151], a[84:87], a[20:23], v[148:151]
    v_exp_f32 v142, v142
    v_mfma_f32_16x16x32_bf16 v[148:151], a[88:91], a[24:27], v[148:151]
    ds_read_b64_tr_b16 a[252:253], v203 offset:57344
    v_mfma_f32_16x16x32_bf16 v[148:151], a[92:95], a[28:31], v[148:151]
    v_exp_f32 v143, v143
    v_mfma_f32_16x16x32_bf16 v[152:155], a[96:99], a[16:19], v[164:167]
    ds_read_b64_tr_b16 a[254:255], v203 offset:61440
    v_perm_b32 v135, v143, v142, s27
    v_mfma_f32_16x16x32_bf16 v[152:155], a[100:103], a[20:23], v[152:155]
    v_xor_b32 v192, 0x10000, v192
    v_xor_b32 v193, 0x10000, v193
    v_mfma_f32_16x16x32_bf16 v[152:155], a[104:107], a[24:27], v[152:155]
    v_exp_f32 v144, v144
    v_mfma_f32_16x16x32_bf16 v[152:155], a[108:111], a[28:31], v[152:155]
    v_xor_b32 v194, 0x10000, v194
    v_xor_b32 v195, 0x10000, v195
    v_mfma_f32_16x16x32_bf16 v[156:159], a[112:115], a[16:19], v[164:167]
    v_exp_f32 v145, v145
    v_mfma_f32_16x16x32_bf16 v[156:159], a[116:119], a[20:23], v[156:159]
    v_perm_b32 v144, v145, v144, s27
    v_xor_b32 v196, 0x10000, v196
    v_mfma_f32_16x16x32_bf16 v[156:159], a[120:123], a[24:27], v[156:159]
    v_exp_f32 v146, v146
    v_mfma_f32_16x16x32_bf16 v[156:159], a[124:127], a[28:31], v[156:159]
    v_xor_b32 v197, 0x10000, v197
    s_waitcnt lgkmcnt(0)
    v_smfmac_f32_16x16x64_bf16 v[176:179], v[204:207], v[128:135], v220
    v_exp_f32 v147, v147
    v_mfma_f32_16x16x32_bf16 v[0:3], a[192:195], v[128:131], v[0:3]
    v_perm_b32 v145, v147, v146, s27
    v_xor_b32 v198, 0x10000, v198
    v_mfma_f32_16x16x32_bf16 v[0:3], a[196:199], v[132:135], v[0:3]
    v_exp_f32 v148, v148
    v_mfma_f32_16x16x32_bf16 v[4:7], a[200:203], v[128:131], v[4:7]
    v_xor_b32 v199, 0x10000, v199
    v_xor_b32 v200, 0x10000, v200
    v_mfma_f32_16x16x32_bf16 v[4:7], a[204:207], v[132:135], v[4:7]
    v_exp_f32 v149, v149
    v_mfma_f32_16x16x32_bf16 v[8:11], a[208:211], v[128:131], v[8:11]
    v_perm_b32 v146, v149, v148, s27
    v_xor_b32 v201, 0x10000, v201
    v_mfma_f32_16x16x32_bf16 v[8:11], a[212:215], v[132:135], v[8:11]
    v_exp_f32 v150, v150
    v_mfma_f32_16x16x32_bf16 v[12:15], a[216:219], v[128:131], v[12:15]
    v_xor_b32 v202, 0x10000, v202
    v_xor_b32 v203, 0x10000, v203
    v_mfma_f32_16x16x32_bf16 v[12:15], a[220:223], v[132:135], v[12:15]
    v_exp_f32 v151, v151
    v_mfma_f32_16x16x32_bf16 v[16:19], a[224:227], v[128:131], v[16:19]
    v_perm_b32 v147, v151, v150, s27
    v_mfma_f32_16x16x32_bf16 v[16:19], a[228:231], v[132:135], v[16:19]
    v_exp_f32 v152, v152
    v_mfma_f32_16x16x32_bf16 v[20:23], a[232:235], v[128:131], v[20:23]
    v_mfma_f32_16x16x32_bf16 v[20:23], a[236:239], v[132:135], v[20:23]
    v_exp_f32 v153, v153
    v_mfma_f32_16x16x32_bf16 v[24:27], a[240:243], v[128:131], v[24:27]
    v_perm_b32 v148, v153, v152, s27
    v_mfma_f32_16x16x32_bf16 v[24:27], a[244:247], v[132:135], v[24:27]
    v_exp_f32 v154, v154
    v_mfma_f32_16x16x32_bf16 v[28:31], a[248:251], v[128:131], v[28:31]
    v_mfma_f32_16x16x32_bf16 v[28:31], a[252:255], v[132:135], v[28:31]
    v_exp_f32 v155, v155
    v_mfma_f32_16x16x32_bf16 v[128:131], a[64:67], a[32:35], v[168:171]
    v_perm_b32 v149, v155, v154, s27
    v_mfma_f32_16x16x32_bf16 v[128:131], a[68:71], a[36:39], v[128:131]
    v_exp_f32 v156, v156
    v_mfma_f32_16x16x32_bf16 v[128:131], a[72:75], a[40:43], v[128:131]
    v_mfma_f32_16x16x32_bf16 v[128:131], a[76:79], a[44:47], v[128:131]
    v_exp_f32 v157, v157
    v_mfma_f32_16x16x32_bf16 v[132:135], a[80:83], a[32:35], v[168:171]
    v_perm_b32 v150, v157, v156, s27
    v_mfma_f32_16x16x32_bf16 v[132:135], a[84:87], a[36:39], v[132:135]
    v_exp_f32 v158, v158
    v_mfma_f32_16x16x32_bf16 v[132:135], a[88:91], a[40:43], v[132:135]
    v_mfma_f32_16x16x32_bf16 v[132:135], a[92:95], a[44:47], v[132:135]
    v_exp_f32 v159, v159
    v_mfma_f32_16x16x32_bf16 v[136:139], a[96:99], a[32:35], v[168:171]
    v_perm_b32 v151, v159, v158, s27
    v_mfma_f32_16x16x32_bf16 v[136:139], a[100:103], a[36:39], v[136:139]
    v_mfma_f32_16x16x32_bf16 v[136:139], a[104:107], a[40:43], v[136:139]
    v_exp_f32 v128, v128
    v_mfma_f32_16x16x32_bf16 v[136:139], a[108:111], a[44:47], v[136:139]
    v_mfma_f32_16x16x32_bf16 v[140:143], a[112:115], a[32:35], v[168:171]
    v_exp_f32 v129, v129
    v_mfma_f32_16x16x32_bf16 v[140:143], a[116:119], a[36:39], v[140:143]
    v_perm_b32 v128, v129, v128, s27
    v_mfma_f32_16x16x32_bf16 v[140:143], a[120:123], a[40:43], v[140:143]
    v_exp_f32 v130, v130
    v_mfma_f32_16x16x32_bf16 v[140:143], a[124:127], a[44:47], v[140:143]
    v_smfmac_f32_16x16x64_bf16 v[180:183], v[204:207], v[144:151], v220
    v_exp_f32 v131, v131
    v_mfma_f32_16x16x32_bf16 v[32:35], a[192:195], v[144:147], v[32:35]
    v_perm_b32 v129, v131, v130, s27
    v_mfma_f32_16x16x32_bf16 v[32:35], a[196:199], v[148:151], v[32:35]
    v_exp_f32 v132, v132
    v_mfma_f32_16x16x32_bf16 v[36:39], a[200:203], v[144:147], v[36:39]
    v_mfma_f32_16x16x32_bf16 v[36:39], a[204:207], v[148:151], v[36:39]
    v_exp_f32 v133, v133
    v_mfma_f32_16x16x32_bf16 v[40:43], a[208:211], v[144:147], v[40:43]
    v_perm_b32 v130, v133, v132, s27
    v_mfma_f32_16x16x32_bf16 v[40:43], a[212:215], v[148:151], v[40:43]
    v_exp_f32 v134, v134
    v_mfma_f32_16x16x32_bf16 v[44:47], a[216:219], v[144:147], v[44:47]
    v_mfma_f32_16x16x32_bf16 v[44:47], a[220:223], v[148:151], v[44:47]
    v_exp_f32 v135, v135
    v_mfma_f32_16x16x32_bf16 v[48:51], a[224:227], v[144:147], v[48:51]
    v_perm_b32 v131, v135, v134, s27
    v_mfma_f32_16x16x32_bf16 v[48:51], a[228:231], v[148:151], v[48:51]
    v_exp_f32 v136, v136
    v_mfma_f32_16x16x32_bf16 v[52:55], a[232:235], v[144:147], v[52:55]
    v_mfma_f32_16x16x32_bf16 v[52:55], a[236:239], v[148:151], v[52:55]
    v_exp_f32 v137, v137
    v_mfma_f32_16x16x32_bf16 v[56:59], a[240:243], v[144:147], v[56:59]
    v_perm_b32 v132, v137, v136, s27
    v_mfma_f32_16x16x32_bf16 v[56:59], a[244:247], v[148:151], v[56:59]
    v_exp_f32 v138, v138
    v_mfma_f32_16x16x32_bf16 v[60:63], a[248:251], v[144:147], v[60:63]
    s_barrier
    v_mfma_f32_16x16x32_bf16 v[60:63], a[252:255], v[148:151], v[60:63]
    v_exp_f32 v139, v139
    v_mfma_f32_16x16x32_bf16 v[144:147], a[64:67], a[48:51], v[172:175]
    ds_read_b128 a[64:67], v192 offset:0
    v_perm_b32 v133, v139, v138, s27
    v_mfma_f32_16x16x32_bf16 v[144:147], a[68:71], a[52:55], v[144:147]
    v_exp_f32 v140, v140
    v_mfma_f32_16x16x32_bf16 v[144:147], a[72:75], a[56:59], v[144:147]
    ds_read_b128 a[68:71], v193 offset:0
    v_mfma_f32_16x16x32_bf16 v[144:147], a[76:79], a[60:63], v[144:147]
    v_exp_f32 v141, v141
    v_mfma_f32_16x16x32_bf16 v[148:151], a[80:83], a[48:51], v[172:175]
    ds_read_b128 a[72:75], v194 offset:0
    v_perm_b32 v134, v141, v140, s27
    v_mfma_f32_16x16x32_bf16 v[148:151], a[84:87], a[52:55], v[148:151]
    v_exp_f32 v142, v142
    v_mfma_f32_16x16x32_bf16 v[148:151], a[88:91], a[56:59], v[148:151]
    ds_read_b128 a[76:79], v195 offset:0
    v_mfma_f32_16x16x32_bf16 v[148:151], a[92:95], a[60:63], v[148:151]
    v_exp_f32 v143, v143
    v_mfma_f32_16x16x32_bf16 v[152:155], a[96:99], a[48:51], v[172:175]
    ds_read_b128 a[80:83], v192 offset:4096
    v_perm_b32 v135, v143, v142, s27
    v_mfma_f32_16x16x32_bf16 v[152:155], a[100:103], a[52:55], v[152:155]
    ds_read_b64_tr_b16 a[128:129], v196 offset:16384
    ds_read_b64_tr_b16 a[130:131], v196 offset:20480
    v_mfma_f32_16x16x32_bf16 v[152:155], a[104:107], a[56:59], v[152:155]
    v_exp_f32 v144, v144
    v_mfma_f32_16x16x32_bf16 v[152:155], a[108:111], a[60:63], v[152:155]
    ds_read_b128 a[84:87], v193 offset:4096
    v_mfma_f32_16x16x32_bf16 v[156:159], a[112:115], a[48:51], v[172:175]
    v_exp_f32 v145, v145
    v_mfma_f32_16x16x32_bf16 v[156:159], a[116:119], a[52:55], v[156:159]
    ds_read_b128 a[88:91], v194 offset:4096
    v_perm_b32 v144, v145, v144, s27
    v_mfma_f32_16x16x32_bf16 v[156:159], a[120:123], a[56:59], v[156:159]
    v_exp_f32 v146, v146
    v_mfma_f32_16x16x32_bf16 v[156:159], a[124:127], a[60:63], v[156:159]
    ds_read_b128 a[92:95], v195 offset:4096
    v_smfmac_f32_16x16x64_bf16 v[184:187], v[204:207], v[128:135], v220
    v_exp_f32 v147, v147
    v_mfma_f32_16x16x32_bf16 v[64:67], a[192:195], v[128:131], v[64:67]
    ds_read_b128 a[96:99], v192 offset:8192
    v_perm_b32 v145, v147, v146, s27
    v_mfma_f32_16x16x32_bf16 v[64:67], a[196:199], v[132:135], v[64:67]
    v_exp_f32 v148, v148
    v_mfma_f32_16x16x32_bf16 v[68:71], a[200:203], v[128:131], v[68:71]
    ds_read_b128 a[100:103], v193 offset:8192
    v_mfma_f32_16x16x32_bf16 v[68:71], a[204:207], v[132:135], v[68:71]
    v_exp_f32 v149, v149
    v_mfma_f32_16x16x32_bf16 v[72:75], a[208:211], v[128:131], v[72:75]
    ds_read_b128 a[104:107], v194 offset:8192
    v_perm_b32 v146, v149, v148, s27
    v_mfma_f32_16x16x32_bf16 v[72:75], a[212:215], v[132:135], v[72:75]
    v_exp_f32 v150, v150
    v_mfma_f32_16x16x32_bf16 v[76:79], a[216:219], v[128:131], v[76:79]
    ds_read_b128 a[108:111], v195 offset:8192
    v_mfma_f32_16x16x32_bf16 v[76:79], a[220:223], v[132:135], v[76:79]
    v_exp_f32 v151, v151
    v_mfma_f32_16x16x32_bf16 v[80:83], a[224:227], v[128:131], v[80:83]
    ds_read_b128 a[112:115], v192 offset:12288
    v_perm_b32 v147, v151, v150, s27
    v_mfma_f32_16x16x32_bf16 v[80:83], a[228:231], v[132:135], v[80:83]
    v_exp_f32 v152, v152
    v_mfma_f32_16x16x32_bf16 v[84:87], a[232:235], v[128:131], v[84:87]
    ds_read_b128 a[116:119], v193 offset:12288
    v_mfma_f32_16x16x32_bf16 v[84:87], a[236:239], v[132:135], v[84:87]
    v_exp_f32 v153, v153
    v_mfma_f32_16x16x32_bf16 v[88:91], a[240:243], v[128:131], v[88:91]
    ds_read_b128 a[120:123], v194 offset:12288
    v_perm_b32 v148, v153, v152, s27
    v_mfma_f32_16x16x32_bf16 v[88:91], a[244:247], v[132:135], v[88:91]
    v_exp_f32 v154, v154
    v_mfma_f32_16x16x32_bf16 v[92:95], a[248:251], v[128:131], v[92:95]
    ds_read_b128 a[124:127], v195 offset:12288
    s_waitcnt lgkmcnt(3)
    v_mfma_f32_16x16x32_bf16 v[92:95], a[252:255], v[132:135], v[92:95]
    v_exp_f32 v155, v155
    v_mfma_f32_16x16x32_bf16 v[128:131], a[64:67], a[0:3], v[160:163]
    ds_read_b64_tr_b16 a[132:133], v196 offset:24576
    v_perm_b32 v149, v155, v154, s27
    v_mfma_f32_16x16x32_bf16 v[128:131], a[68:71], a[4:7], v[128:131]
    v_exp_f32 v156, v156
    v_mfma_f32_16x16x32_bf16 v[128:131], a[72:75], a[8:11], v[128:131]
    ds_read_b64_tr_b16 a[134:135], v196 offset:28672
    ds_read_b64_tr_b16 a[136:137], v197 offset:16384
    v_mfma_f32_16x16x32_bf16 v[128:131], a[76:79], a[12:15], v[128:131]
    v_exp_f32 v157, v157
    v_mfma_f32_16x16x32_bf16 v[132:135], a[80:83], a[0:3], v[160:163]
    ds_read_b64_tr_b16 a[138:139], v197 offset:20480
    v_perm_b32 v150, v157, v156, s27
    v_mfma_f32_16x16x32_bf16 v[132:135], a[84:87], a[4:7], v[132:135]
    v_exp_f32 v158, v158
    v_mfma_f32_16x16x32_bf16 v[132:135], a[88:91], a[8:11], v[132:135]
    ds_read_b64_tr_b16 a[140:141], v197 offset:24576
    ds_read_b64_tr_b16 a[142:143], v197 offset:28672
    v_mfma_f32_16x16x32_bf16 v[132:135], a[92:95], a[12:15], v[132:135]
    v_exp_f32 v159, v159
    v_mfma_f32_16x16x32_bf16 v[136:139], a[96:99], a[0:3], v[160:163]
    ds_read_b64_tr_b16 a[144:145], v198 offset:16384
    v_perm_b32 v151, v159, v158, s27
    v_mfma_f32_16x16x32_bf16 v[136:139], a[100:103], a[4:7], v[136:139]
    ds_read_b64_tr_b16 a[146:147], v198 offset:20480
    ds_read_b64_tr_b16 a[148:149], v198 offset:24576
    v_mfma_f32_16x16x32_bf16 v[136:139], a[104:107], a[8:11], v[136:139]
    v_exp_f32 v128, v128
    v_mfma_f32_16x16x32_bf16 v[136:139], a[108:111], a[12:15], v[136:139]
    ds_read_b64_tr_b16 a[150:151], v198 offset:28672
    s_waitcnt lgkmcnt(10)
    v_mfma_f32_16x16x32_bf16 v[140:143], a[112:115], a[0:3], v[160:163]
    v_exp_f32 v129, v129
    v_mfma_f32_16x16x32_bf16 v[140:143], a[116:119], a[4:7], v[140:143]
    ds_read_b64_tr_b16 a[152:153], v199 offset:16384
    v_perm_b32 v128, v129, v128, s27
    v_mfma_f32_16x16x32_bf16 v[140:143], a[120:123], a[8:11], v[140:143]
    v_exp_f32 v130, v130
    v_mfma_f32_16x16x32_bf16 v[140:143], a[124:127], a[12:15], v[140:143]
    ds_read_b64_tr_b16 a[154:155], v199 offset:20480
    ds_read_b64_tr_b16 a[156:157], v199 offset:24576
    v_smfmac_f32_16x16x64_bf16 v[188:191], v[204:207], v[144:151], v220
    v_exp_f32 v131, v131
    v_mfma_f32_16x16x32_bf16 v[96:99], a[192:195], v[144:147], v[96:99]
    ds_read_b64_tr_b16 a[158:159], v199 offset:28672
    v_perm_b32 v129, v131, v130, s27
    v_mfma_f32_16x16x32_bf16 v[96:99], a[196:199], v[148:151], v[96:99]
    v_exp_f32 v132, v132
    v_mfma_f32_16x16x32_bf16 v[100:103], a[200:203], v[144:147], v[100:103]
    ds_read_b64_tr_b16 a[160:161], v200 offset:16384
    ds_read_b64_tr_b16 a[162:163], v200 offset:20480
    v_mfma_f32_16x16x32_bf16 v[100:103], a[204:207], v[148:151], v[100:103]
    v_exp_f32 v133, v133
    v_mfma_f32_16x16x32_bf16 v[104:107], a[208:211], v[144:147], v[104:107]
    ds_read_b64_tr_b16 a[164:165], v200 offset:24576
    v_perm_b32 v130, v133, v132, s27
    v_mfma_f32_16x16x32_bf16 v[104:107], a[212:215], v[148:151], v[104:107]
    v_exp_f32 v134, v134
    v_mfma_f32_16x16x32_bf16 v[108:111], a[216:219], v[144:147], v[108:111]
    ds_read_b64_tr_b16 a[166:167], v200 offset:28672
    ds_read_b64_tr_b16 a[168:169], v201 offset:16384
    v_mfma_f32_16x16x32_bf16 v[108:111], a[220:223], v[148:151], v[108:111]
    v_exp_f32 v135, v135
    v_mfma_f32_16x16x32_bf16 v[112:115], a[224:227], v[144:147], v[112:115]
    v_perm_b32 v131, v135, v134, s27
    v_mfma_f32_16x16x32_bf16 v[112:115], a[228:231], v[148:151], v[112:115]
    v_exp_f32 v136, v136
    v_mfma_f32_16x16x32_bf16 v[116:119], a[232:235], v[144:147], v[116:119]
    ds_read_b64_tr_b16 a[170:171], v201 offset:20480
    ds_read_b64_tr_b16 a[172:173], v201 offset:24576
    v_mfma_f32_16x16x32_bf16 v[116:119], a[236:239], v[148:151], v[116:119]
    v_exp_f32 v137, v137
    v_mfma_f32_16x16x32_bf16 v[120:123], a[240:243], v[144:147], v[120:123]
    ds_read_b64_tr_b16 a[174:175], v201 offset:28672
    v_perm_b32 v132, v137, v136, s27
    v_mfma_f32_16x16x32_bf16 v[120:123], a[244:247], v[148:151], v[120:123]
    v_exp_f32 v138, v138
    v_mfma_f32_16x16x32_bf16 v[124:127], a[248:251], v[144:147], v[124:127]
    ds_read_b64_tr_b16 a[176:177], v202 offset:16384
    ds_read_b64_tr_b16 a[178:179], v202 offset:20480
    v_mfma_f32_16x16x32_bf16 v[124:127], a[252:255], v[148:151], v[124:127]
    v_exp_f32 v139, v139
    v_mfma_f32_16x16x32_bf16 v[144:147], a[64:67], a[16:19], v[164:167]
    ds_read_b64_tr_b16 a[180:181], v202 offset:24576
    v_perm_b32 v133, v139, v138, s27
    v_mfma_f32_16x16x32_bf16 v[144:147], a[68:71], a[20:23], v[144:147]
    v_exp_f32 v140, v140
    v_mfma_f32_16x16x32_bf16 v[144:147], a[72:75], a[24:27], v[144:147]
    ds_read_b64_tr_b16 a[182:183], v202 offset:28672
    ds_read_b64_tr_b16 a[184:185], v203 offset:16384
    v_mfma_f32_16x16x32_bf16 v[144:147], a[76:79], a[28:31], v[144:147]
    v_exp_f32 v141, v141
    v_mfma_f32_16x16x32_bf16 v[148:151], a[80:83], a[16:19], v[164:167]
    ds_read_b64_tr_b16 a[186:187], v203 offset:20480
    v_perm_b32 v134, v141, v140, s27
    v_mfma_f32_16x16x32_bf16 v[148:151], a[84:87], a[20:23], v[148:151]
    v_exp_f32 v142, v142
    v_mfma_f32_16x16x32_bf16 v[148:151], a[88:91], a[24:27], v[148:151]
    ds_read_b64_tr_b16 a[188:189], v203 offset:24576
    v_mfma_f32_16x16x32_bf16 v[148:151], a[92:95], a[28:31], v[148:151]
    v_exp_f32 v143, v143
    v_mfma_f32_16x16x32_bf16 v[152:155], a[96:99], a[16:19], v[164:167]
    ds_read_b64_tr_b16 a[190:191], v203 offset:28672
    v_perm_b32 v135, v143, v142, s27
    v_mfma_f32_16x16x32_bf16 v[152:155], a[100:103], a[20:23], v[152:155]
    v_mfma_f32_16x16x32_bf16 v[152:155], a[104:107], a[24:27], v[152:155]
    v_exp_f32 v144, v144
    v_mfma_f32_16x16x32_bf16 v[152:155], a[108:111], a[28:31], v[152:155]
    v_mfma_f32_16x16x32_bf16 v[156:159], a[112:115], a[16:19], v[164:167]
    v_exp_f32 v145, v145
    v_mfma_f32_16x16x32_bf16 v[156:159], a[116:119], a[20:23], v[156:159]
    v_perm_b32 v144, v145, v144, s27
    v_mfma_f32_16x16x32_bf16 v[156:159], a[120:123], a[24:27], v[156:159]
    v_exp_f32 v146, v146
    v_mfma_f32_16x16x32_bf16 v[156:159], a[124:127], a[28:31], v[156:159]
    s_waitcnt lgkmcnt(0)
    v_smfmac_f32_16x16x64_bf16 v[176:179], v[204:207], v[128:135], v220
    v_exp_f32 v147, v147
    v_mfma_f32_16x16x32_bf16 v[0:3], a[128:131], v[128:131], v[0:3]
    v_perm_b32 v145, v147, v146, s27
    v_mfma_f32_16x16x32_bf16 v[0:3], a[132:135], v[132:135], v[0:3]
    v_exp_f32 v148, v148
    v_mfma_f32_16x16x32_bf16 v[4:7], a[136:139], v[128:131], v[4:7]
    v_mfma_f32_16x16x32_bf16 v[4:7], a[140:143], v[132:135], v[4:7]
    v_exp_f32 v149, v149
    v_mfma_f32_16x16x32_bf16 v[8:11], a[144:147], v[128:131], v[8:11]
    v_perm_b32 v146, v149, v148, s27
    v_mfma_f32_16x16x32_bf16 v[8:11], a[148:151], v[132:135], v[8:11]
    v_exp_f32 v150, v150
    v_mfma_f32_16x16x32_bf16 v[12:15], a[152:155], v[128:131], v[12:15]
    v_mfma_f32_16x16x32_bf16 v[12:15], a[156:159], v[132:135], v[12:15]
    v_exp_f32 v151, v151
    v_mfma_f32_16x16x32_bf16 v[16:19], a[160:163], v[128:131], v[16:19]
    v_perm_b32 v147, v151, v150, s27
    v_mfma_f32_16x16x32_bf16 v[16:19], a[164:167], v[132:135], v[16:19]
    v_exp_f32 v152, v152
    v_mfma_f32_16x16x32_bf16 v[20:23], a[168:171], v[128:131], v[20:23]
    v_mfma_f32_16x16x32_bf16 v[20:23], a[172:175], v[132:135], v[20:23]
    v_exp_f32 v153, v153
    v_mfma_f32_16x16x32_bf16 v[24:27], a[176:179], v[128:131], v[24:27]
    v_perm_b32 v148, v153, v152, s27
    v_mfma_f32_16x16x32_bf16 v[24:27], a[180:183], v[132:135], v[24:27]
    v_exp_f32 v154, v154
    v_mfma_f32_16x16x32_bf16 v[28:31], a[184:187], v[128:131], v[28:31]
    v_mfma_f32_16x16x32_bf16 v[28:31], a[188:191], v[132:135], v[28:31]
    v_exp_f32 v155, v155
    v_mfma_f32_16x16x32_bf16 v[128:131], a[64:67], a[32:35], v[168:171]
    v_perm_b32 v149, v155, v154, s27
    v_mfma_f32_16x16x32_bf16 v[128:131], a[68:71], a[36:39], v[128:131]
    v_exp_f32 v156, v156
    v_mfma_f32_16x16x32_bf16 v[128:131], a[72:75], a[40:43], v[128:131]
    v_mfma_f32_16x16x32_bf16 v[128:131], a[76:79], a[44:47], v[128:131]
    v_exp_f32 v157, v157
    v_mfma_f32_16x16x32_bf16 v[132:135], a[80:83], a[32:35], v[168:171]
    v_perm_b32 v150, v157, v156, s27
    v_mfma_f32_16x16x32_bf16 v[132:135], a[84:87], a[36:39], v[132:135]
    v_exp_f32 v158, v158
    v_mfma_f32_16x16x32_bf16 v[132:135], a[88:91], a[40:43], v[132:135]
    v_mfma_f32_16x16x32_bf16 v[132:135], a[92:95], a[44:47], v[132:135]
    v_exp_f32 v159, v159
    v_mfma_f32_16x16x32_bf16 v[136:139], a[96:99], a[32:35], v[168:171]
    v_perm_b32 v151, v159, v158, s27
    v_mfma_f32_16x16x32_bf16 v[136:139], a[100:103], a[36:39], v[136:139]
    v_mfma_f32_16x16x32_bf16 v[136:139], a[104:107], a[40:43], v[136:139]
    v_exp_f32 v128, v128
    v_mfma_f32_16x16x32_bf16 v[136:139], a[108:111], a[44:47], v[136:139]
    v_mfma_f32_16x16x32_bf16 v[140:143], a[112:115], a[32:35], v[168:171]
    v_exp_f32 v129, v129
    v_mfma_f32_16x16x32_bf16 v[140:143], a[116:119], a[36:39], v[140:143]
    v_perm_b32 v128, v129, v128, s27
    v_mfma_f32_16x16x32_bf16 v[140:143], a[120:123], a[40:43], v[140:143]
    v_exp_f32 v130, v130
    v_mfma_f32_16x16x32_bf16 v[140:143], a[124:127], a[44:47], v[140:143]
    v_smfmac_f32_16x16x64_bf16 v[180:183], v[204:207], v[144:151], v220
    v_exp_f32 v131, v131
    v_mfma_f32_16x16x32_bf16 v[32:35], a[128:131], v[144:147], v[32:35]
    v_perm_b32 v129, v131, v130, s27
    v_mfma_f32_16x16x32_bf16 v[32:35], a[132:135], v[148:151], v[32:35]
    v_exp_f32 v132, v132
    v_mfma_f32_16x16x32_bf16 v[36:39], a[136:139], v[144:147], v[36:39]
    v_mfma_f32_16x16x32_bf16 v[36:39], a[140:143], v[148:151], v[36:39]
    v_exp_f32 v133, v133
    v_mfma_f32_16x16x32_bf16 v[40:43], a[144:147], v[144:147], v[40:43]
    v_perm_b32 v130, v133, v132, s27
    v_mfma_f32_16x16x32_bf16 v[40:43], a[148:151], v[148:151], v[40:43]
    v_exp_f32 v134, v134
    v_mfma_f32_16x16x32_bf16 v[44:47], a[152:155], v[144:147], v[44:47]
    v_mfma_f32_16x16x32_bf16 v[44:47], a[156:159], v[148:151], v[44:47]
    v_exp_f32 v135, v135
    v_mfma_f32_16x16x32_bf16 v[48:51], a[160:163], v[144:147], v[48:51]
    v_perm_b32 v131, v135, v134, s27
    v_mfma_f32_16x16x32_bf16 v[48:51], a[164:167], v[148:151], v[48:51]
    v_exp_f32 v136, v136
    v_mfma_f32_16x16x32_bf16 v[52:55], a[168:171], v[144:147], v[52:55]
    v_mfma_f32_16x16x32_bf16 v[52:55], a[172:175], v[148:151], v[52:55]
    v_exp_f32 v137, v137
    v_mfma_f32_16x16x32_bf16 v[56:59], a[176:179], v[144:147], v[56:59]
    v_perm_b32 v132, v137, v136, s27
    v_mfma_f32_16x16x32_bf16 v[56:59], a[180:183], v[148:151], v[56:59]
    v_exp_f32 v138, v138
    v_mfma_f32_16x16x32_bf16 v[60:63], a[184:187], v[144:147], v[60:63]
    s_barrier
    v_mfma_f32_16x16x32_bf16 v[60:63], a[188:191], v[148:151], v[60:63]
    v_exp_f32 v139, v139
    s_branch L_evenA
L_loopB:
.p2align 6
L_evenB:
    s_waitcnt vmcnt(48)
    s_barrier
    v_mfma_f32_16x16x32_bf16 v[144:147], a[64:67], a[32:35], v[168:171]
    ds_read_b128 a[64:67], v192 offset:32768
    v_perm_b32 v133, v139, v138, s27
    s_add_u32 m0, s25, 0
    v_mfma_f32_16x16x32_bf16 v[144:147], a[68:71], a[36:39], v[144:147]
    buffer_load_dwordx4 v212, s[8:11], s23 offen offset:0 sc0 sc1 nt lds
    v_exp_f32 v140, v140
    v_mfma_f32_16x16x32_bf16 v[144:147], a[72:75], a[40:43], v[144:147]
    ds_read_b128 a[68:71], v193 offset:32768
    s_add_u32 s26, s26, 1
    v_mfma_f32_16x16x32_bf16 v[144:147], a[76:79], a[44:47], v[144:147]
    buffer_load_dwordx4 v213, s[8:11], s23 offen offset:1024 sc0 sc1 nt lds
    v_exp_f32 v141, v141
    v_mfma_f32_16x16x32_bf16 v[148:151], a[80:83], a[32:35], v[168:171]
    ds_read_b128 a[72:75], v194 offset:32768
    v_perm_b32 v134, v141, v140, s27
    v_mfma_f32_16x16x32_bf16 v[148:151], a[84:87], a[36:39], v[148:151]
    v_exp_f32 v142, v142
    v_mfma_f32_16x16x32_bf16 v[148:151], a[88:91], a[40:43], v[148:151]
    ds_read_b128 a[76:79], v195 offset:32768
    buffer_load_dwordx4 v212, s[8:11], s23 offen offset:2048 sc0 sc1 nt lds
    v_mfma_f32_16x16x32_bf16 v[148:151], a[92:95], a[44:47], v[148:151]
    v_exp_f32 v143, v143
    v_mfma_f32_16x16x32_bf16 v[152:155], a[96:99], a[32:35], v[168:171]
    ds_read_b128 a[80:83], v192 offset:36864
    v_perm_b32 v135, v143, v142, s27
    v_mfma_f32_16x16x32_bf16 v[152:155], a[100:103], a[36:39], v[152:155]
    ds_read_b64_tr_b16 a[192:193], v196 offset:49152
    ds_read_b64_tr_b16 a[194:195], v196 offset:53248
    buffer_load_dwordx4 v213, s[8:11], s23 offen offset:3072 sc0 sc1 nt lds
    v_mfma_f32_16x16x32_bf16 v[152:155], a[104:107], a[40:43], v[152:155]
    v_exp_f32 v144, v144
    s_add_u32 m0, s25, 4096
    v_mfma_f32_16x16x32_bf16 v[152:155], a[108:111], a[44:47], v[152:155]
    ds_read_b128 a[84:87], v193 offset:36864
    v_mfma_f32_16x16x32_bf16 v[156:159], a[112:115], a[32:35], v[168:171]
    buffer_load_dwordx4 v108, s[8:11], s23 offen offset:0 sc0 sc1 nt lds
    v_exp_f32 v145, v145
    v_mfma_f32_16x16x32_bf16 v[156:159], a[116:119], a[36:39], v[156:159]
    ds_read_b128 a[88:91], v194 offset:36864
    v_perm_b32 v144, v145, v144, s27
    v_mfma_f32_16x16x32_bf16 v[156:159], a[120:123], a[40:43], v[156:159]
    v_exp_f32 v146, v146
    v_mfma_f32_16x16x32_bf16 v[156:159], a[124:127], a[44:47], v[156:159]
    ds_read_b128 a[92:95], v195 offset:36864
    buffer_load_dwordx4 v109, s[8:11], s23 offen offset:1024 sc0 sc1 nt lds
    v_smfmac_f32_16x16x64_bf16 v[180:183], v[204:207], v[128:135], v220
    v_exp_f32 v147, v147
    v_mfma_f32_16x16x32_bf16 v[32:35], a[128:131], v[128:131], v[32:35]
    ds_read_b128 a[96:99], v192 offset:40960
    v_perm_b32 v145, v147, v146, s27
    v_mfma_f32_16x16x32_bf16 v[32:35], a[132:135], v[132:135], v[32:35]
    buffer_load_dwordx4 v108, s[8:11], s23 offen offset:2048 sc0 sc1 nt lds
    v_exp_f32 v148, v148
    v_mfma_f32_16x16x32_bf16 v[36:39], a[136:139], v[128:131], v[36:39]
    ds_read_b128 a[100:103], v193 offset:40960
    v_mfma_f32_16x16x32_bf16 v[36:39], a[140:143], v[132:135], v[36:39]
    buffer_load_dwordx4 v109, s[8:11], s23 offen offset:3072 sc0 sc1 nt lds
    v_exp_f32 v149, v149
    v_mfma_f32_16x16x32_bf16 v[40:43], a[144:147], v[128:131], v[40:43]
    ds_read_b128 a[104:107], v194 offset:40960
    v_perm_b32 v146, v149, v148, s27
    s_add_u32 m0, s25, 8192
    v_mfma_f32_16x16x32_bf16 v[40:43], a[148:151], v[132:135], v[40:43]
    v_exp_f32 v150, v150
    v_mfma_f32_16x16x32_bf16 v[44:47], a[152:155], v[128:131], v[44:47]
    ds_read_b128 a[108:111], v195 offset:40960
    buffer_load_dwordx4 v110, s[8:11], s23 offen offset:0 sc0 sc1 nt lds
    v_mfma_f32_16x16x32_bf16 v[44:47], a[156:159], v[132:135], v[44:47]
    v_exp_f32 v151, v151
    v_mfma_f32_16x16x32_bf16 v[48:51], a[160:163], v[128:131], v[48:51]
    ds_read_b128 a[112:115], v192 offset:45056
    v_perm_b32 v147, v151, v150, s27
    v_mfma_f32_16x16x32_bf16 v[48:51], a[164:167], v[132:135], v[48:51]
    buffer_load_dwordx4 v111, s[8:11], s23 offen offset:1024 sc0 sc1 nt lds
    v_exp_f32 v152, v152
    v_mfma_f32_16x16x32_bf16 v[52:55], a[168:171], v[128:131], v[52:55]
    ds_read_b128 a[116:119], v193 offset:45056
    v_mfma_f32_16x16x32_bf16 v[52:55], a[172:175], v[132:135], v[52:55]
    v_exp_f32 v153, v153
    v_mfma_f32_16x16x32_bf16 v[56:59], a[176:179], v[128:131], v[56:59]
    ds_read_b128 a[120:123], v194 offset:45056
    buffer_load_dwordx4 v110, s[8:11], s23 offen offset:2048 sc0 sc1 nt lds
    v_perm_b32 v148, v153, v152, s27
    v_mfma_f32_16x16x32_bf16 v[56:59], a[180:183], v[132:135], v[56:59]
    v_exp_f32 v154, v154
    v_mfma_f32_16x16x32_bf16 v[60:63], a[184:187], v[128:131], v[60:63]
    ds_read_b128 a[124:127], v195 offset:45056
    v_mfma_f32_16x16x32_bf16 v[60:63], a[188:191], v[132:135], v[60:63]
    v_exp_f32 v155, v155
    s_waitcnt lgkmcnt(2)
    v_mfma_f32_16x16x32_bf16 v[128:131], a[64:67], a[0:3], v[160:163]
    ds_read_b64_tr_b16 a[196:197], v196 offset:57344
    buffer_load_dwordx4 v111, s[8:11], s23 offen offset:3072 sc0 sc1 nt lds
    v_perm_b32 v149, v155, v154, s27
    v_mfma_f32_16x16x32_bf16 v[128:131], a[68:71], a[4:7], v[128:131]
    v_exp_f32 v156, v156
    s_add_u32 m0, s25, 12288
    v_mfma_f32_16x16x32_bf16 v[128:131], a[72:75], a[8:11], v[128:131]
    ds_read_b64_tr_b16 a[198:199], v196 offset:61440
    ds_read_b64_tr_b16 a[200:201], v197 offset:49152
    buffer_load_dwordx4 v112, s[8:11], s23 offen offset:0 sc0 sc1 nt lds
    v_mfma_f32_16x16x32_bf16 v[128:131], a[76:79], a[12:15], v[128:131]
    v_exp_f32 v157, v157
    v_mfma_f32_16x16x32_bf16 v[132:135], a[80:83], a[0:3], v[160:163]
    ds_read_b64_tr_b16 a[202:203], v197 offset:53248
    buffer_load_dwordx4 v113, s[8:11], s23 offen offset:1024 sc0 sc1 nt lds
    v_perm_b32 v150, v157, v156, s27
    v_mfma_f32_16x16x32_bf16 v[132:135], a[84:87], a[4:7], v[132:135]
    v_exp_f32 v158, v158
    v_mfma_f32_16x16x32_bf16 v[132:135], a[88:91], a[8:11], v[132:135]
    ds_read_b64_tr_b16 a[204:205], v197 offset:57344
    ds_read_b64_tr_b16 a[206:207], v197 offset:61440
    v_mfma_f32_16x16x32_bf16 v[132:135], a[92:95], a[12:15], v[132:135]
    buffer_load_dwordx4 v112, s[8:11], s23 offen offset:2048 sc0 sc1 nt lds
    v_exp_f32 v159, v159
    v_mfma_f32_16x16x32_bf16 v[136:139], a[96:99], a[0:3], v[160:163]
    ds_read_b64_tr_b16 a[208:209], v198 offset:49152
    v_perm_b32 v151, v159, v158, s27
    v_mfma_f32_16x16x32_bf16 v[136:139], a[100:103], a[4:7], v[136:139]
    ds_read_b64_tr_b16 a[210:211], v198 offset:53248
    ds_read_b64_tr_b16 a[212:213], v198 offset:57344
    v_mfma_f32_16x16x32_bf16 v[136:139], a[104:107], a[8:11], v[136:139]
    buffer_load_dwordx4 v113, s[8:11], s23 offen offset:3072 sc0 sc1 nt lds
    v_exp_f32 v128, v128
    s_add_u32 s23, s23, 16384
    v_mfma_f32_16x16x32_bf16 v[136:139], a[108:111], a[12:15], v[136:139]
    ds_read_b64_tr_b16 a[214:215], v198 offset:61440
    s_add_u32 s25, s24, 16384
    s_add_u32 m0, s24, 0
    s_waitcnt lgkmcnt(10)
    v_mfma_f32_16x16x32_bf16 v[140:143], a[112:115], a[0:3], v[160:163]
    v_exp_f32 v129, v129
    v_mfma_f32_16x16x32_bf16 v[140:143], a[116:119], a[4:7], v[140:143]
    ds_read_b64_tr_b16 a[216:217], v199 offset:49152
    buffer_load_dwordx4 v208, s[4:7], s22 offen offset:0 sc0 sc1 nt lds
    v_perm_b32 v128, v129, v128, s27
    v_mfma_f32_16x16x32_bf16 v[140:143], a[120:123], a[8:11], v[140:143]
    v_exp_f32 v130, v130
    v_mfma_f32_16x16x32_bf16 v[140:143], a[124:127], a[12:15], v[140:143]
    ds_read_b64_tr_b16 a[218:219], v199 offset:53248
    ds_read_b64_tr_b16 a[220:221], v199 offset:57344
    v_smfmac_f32_16x16x64_bf16 v[184:187], v[204:207], v[144:151], v220
    buffer_load_dwordx4 v209, s[4:7], s22 offen offset:1024 sc0 sc1 nt lds
    v_exp_f32 v131, v131
    v_mfma_f32_16x16x32_bf16 v[64:67], a[128:131], v[144:147], v[64:67]
    ds_read_b64_tr_b16 a[222:223], v199 offset:61440
    v_perm_b32 v129, v131, v130, s27
    v_mfma_f32_16x16x32_bf16 v[64:67], a[132:135], v[148:151], v[64:67]
    v_exp_f32 v132, v132
    v_mfma_f32_16x16x32_bf16 v[68:71], a[136:139], v[144:147], v[68:71]
    ds_read_b64_tr_b16 a[224:225], v200 offset:49152
    ds_read_b64_tr_b16 a[226:227], v200 offset:53248
    buffer_load_dwordx4 v210, s[4:7], s22 offen offset:2048 sc0 sc1 nt lds
    v_mfma_f32_16x16x32_bf16 v[68:71], a[140:143], v[148:151], v[68:71]
    v_exp_f32 v133, v133
    v_mfma_f32_16x16x32_bf16 v[72:75], a[144:147], v[144:147], v[72:75]
    ds_read_b64_tr_b16 a[228:229], v200 offset:57344
    v_perm_b32 v130, v133, v132, s27
    v_mfma_f32_16x16x32_bf16 v[72:75], a[148:151], v[148:151], v[72:75]
    buffer_load_dwordx4 v211, s[4:7], s22 offen offset:3072 sc0 sc1 nt lds
    v_exp_f32 v134, v134
    v_mfma_f32_16x16x32_bf16 v[76:79], a[152:155], v[144:147], v[76:79]
    ds_read_b64_tr_b16 a[230:231], v200 offset:61440
    ds_read_b64_tr_b16 a[232:233], v201 offset:49152
    s_add_u32 m0, s24, 4096
    v_mfma_f32_16x16x32_bf16 v[76:79], a[156:159], v[148:151], v[76:79]
    buffer_load_dwordx4 v96, s[4:7], s22 offen offset:0 sc0 sc1 nt lds
    v_exp_f32 v135, v135
    v_mfma_f32_16x16x32_bf16 v[80:83], a[160:163], v[144:147], v[80:83]
    v_perm_b32 v131, v135, v134, s27
    v_mfma_f32_16x16x32_bf16 v[80:83], a[164:167], v[148:151], v[80:83]
    v_exp_f32 v136, v136
    v_mfma_f32_16x16x32_bf16 v[84:87], a[168:171], v[144:147], v[84:87]
    ds_read_b64_tr_b16 a[234:235], v201 offset:53248
    ds_read_b64_tr_b16 a[236:237], v201 offset:57344
    buffer_load_dwordx4 v97, s[4:7], s22 offen offset:1024 sc0 sc1 nt lds
    v_mfma_f32_16x16x32_bf16 v[84:87], a[172:175], v[148:151], v[84:87]
    v_exp_f32 v137, v137
    v_mfma_f32_16x16x32_bf16 v[88:91], a[176:179], v[144:147], v[88:91]
    ds_read_b64_tr_b16 a[238:239], v201 offset:61440
    v_perm_b32 v132, v137, v136, s27
    v_mfma_f32_16x16x32_bf16 v[88:91], a[180:183], v[148:151], v[88:91]
    buffer_load_dwordx4 v98, s[4:7], s22 offen offset:2048 sc0 sc1 nt lds
    v_exp_f32 v138, v138
    v_mfma_f32_16x16x32_bf16 v[92:95], a[184:187], v[144:147], v[92:95]
    ds_read_b64_tr_b16 a[240:241], v202 offset:49152
    ds_read_b64_tr_b16 a[242:243], v202 offset:53248
    v_mfma_f32_16x16x32_bf16 v[92:95], a[188:191], v[148:151], v[92:95]
    v_exp_f32 v139, v139
    s_cmp_eq_u32 s26, 16
    s_cbranch_scc1 L_tailB
L_entryB:
    v_mfma_f32_16x16x32_bf16 v[144:147], a[64:67], a[16:19], v[164:167]
    ds_read_b64_tr_b16 a[244:245], v202 offset:57344
    buffer_load_dwordx4 v99, s[4:7], s22 offen offset:3072 sc0 sc1 nt lds
    v_perm_b32 v133, v139, v138, s27
    v_mfma_f32_16x16x32_bf16 v[144:147], a[68:71], a[20:23], v[144:147]
    v_exp_f32 v140, v140
    s_add_u32 m0, s24, 8192
    v_mfma_f32_16x16x32_bf16 v[144:147], a[72:75], a[24:27], v[144:147]
    ds_read_b64_tr_b16 a[246:247], v202 offset:61440
    ds_read_b64_tr_b16 a[248:249], v203 offset:49152
    v_mfma_f32_16x16x32_bf16 v[144:147], a[76:79], a[28:31], v[144:147]
    buffer_load_dwordx4 v100, s[4:7], s22 offen offset:0 sc0 sc1 nt lds
    v_exp_f32 v141, v141
    v_mfma_f32_16x16x32_bf16 v[148:151], a[80:83], a[16:19], v[164:167]
    ds_read_b64_tr_b16 a[250:251], v203 offset:53248
    v_perm_b32 v134, v141, v140, s27
    v_mfma_f32_16x16x32_bf16 v[148:151], a[84:87], a[20:23], v[148:151]
    v_exp_f32 v142, v142
    v_mfma_f32_16x16x32_bf16 v[148:151], a[88:91], a[24:27], v[148:151]
    ds_read_b64_tr_b16 a[252:253], v203 offset:57344
    buffer_load_dwordx4 v101, s[4:7], s22 offen offset:1024 sc0 sc1 nt lds
    v_mfma_f32_16x16x32_bf16 v[148:151], a[92:95], a[28:31], v[148:151]
    v_exp_f32 v143, v143
    v_mfma_f32_16x16x32_bf16 v[152:155], a[96:99], a[16:19], v[164:167]
    ds_read_b64_tr_b16 a[254:255], v203 offset:61440
    buffer_load_dwordx4 v102, s[4:7], s22 offen offset:2048 sc0 sc1 nt lds
    v_perm_b32 v135, v143, v142, s27
    v_mfma_f32_16x16x32_bf16 v[152:155], a[100:103], a[20:23], v[152:155]
    v_xor_b32 v192, 0x10000, v192
    v_xor_b32 v193, 0x10000, v193
    v_mfma_f32_16x16x32_bf16 v[152:155], a[104:107], a[24:27], v[152:155]
    v_exp_f32 v144, v144
    v_mfma_f32_16x16x32_bf16 v[152:155], a[108:111], a[28:31], v[152:155]
    buffer_load_dwordx4 v103, s[4:7], s22 offen offset:3072 sc0 sc1 nt lds
    v_xor_b32 v194, 0x10000, v194
    v_xor_b32 v195, 0x10000, v195
    v_mfma_f32_16x16x32_bf16 v[156:159], a[112:115], a[16:19], v[164:167]
    v_exp_f32 v145, v145
    s_add_u32 m0, s24, 12288
    v_mfma_f32_16x16x32_bf16 v[156:159], a[116:119], a[20:23], v[156:159]
    v_perm_b32 v144, v145, v144, s27
    v_xor_b32 v196, 0x10000, v196
    v_mfma_f32_16x16x32_bf16 v[156:159], a[120:123], a[24:27], v[156:159]
    buffer_load_dwordx4 v104, s[4:7], s22 offen offset:0 sc0 sc1 nt lds
    v_exp_f32 v146, v146
    v_mfma_f32_16x16x32_bf16 v[156:159], a[124:127], a[28:31], v[156:159]
    v_xor_b32 v197, 0x10000, v197
    s_waitcnt lgkmcnt(0)
    v_smfmac_f32_16x16x64_bf16 v[176:179], v[204:207], v[128:135], v220
    v_exp_f32 v147, v147
    v_mfma_f32_16x16x32_bf16 v[0:3], a[192:195], v[128:131], v[0:3]
    buffer_load_dwordx4 v105, s[4:7], s22 offen offset:1024 sc0 sc1 nt lds
    v_perm_b32 v145, v147, v146, s27
    v_xor_b32 v198, 0x10000, v198
    v_mfma_f32_16x16x32_bf16 v[0:3], a[196:199], v[132:135], v[0:3]
    v_exp_f32 v148, v148
    v_mfma_f32_16x16x32_bf16 v[4:7], a[200:203], v[128:131], v[4:7]
    v_xor_b32 v199, 0x10000, v199
    v_xor_b32 v200, 0x10000, v200
    v_mfma_f32_16x16x32_bf16 v[4:7], a[204:207], v[132:135], v[4:7]
    buffer_load_dwordx4 v106, s[4:7], s22 offen offset:2048 sc0 sc1 nt lds
    v_exp_f32 v149, v149
    v_mfma_f32_16x16x32_bf16 v[8:11], a[208:211], v[128:131], v[8:11]
    v_perm_b32 v146, v149, v148, s27
    v_xor_b32 v201, 0x10000, v201
    v_mfma_f32_16x16x32_bf16 v[8:11], a[212:215], v[132:135], v[8:11]
    v_exp_f32 v150, v150
    v_mfma_f32_16x16x32_bf16 v[12:15], a[216:219], v[128:131], v[12:15]
    buffer_load_dwordx4 v107, s[4:7], s22 offen offset:3072 sc0 sc1 nt lds
    v_xor_b32 v202, 0x10000, v202
    v_xor_b32 v203, 0x10000, v203
    s_add_u32 s22, s22, 16384
    v_mfma_f32_16x16x32_bf16 v[12:15], a[220:223], v[132:135], v[12:15]
    v_exp_f32 v151, v151
    s_add_u32 s24, s24, 32768
    v_mfma_f32_16x16x32_bf16 v[16:19], a[224:227], v[128:131], v[16:19]
    v_perm_b32 v147, v151, v150, s27
    s_and_b32 s24, s24, 0x1ffff
    v_mfma_f32_16x16x32_bf16 v[16:19], a[228:231], v[132:135], v[16:19]
    v_exp_f32 v152, v152
    v_mfma_f32_16x16x32_bf16 v[20:23], a[232:235], v[128:131], v[20:23]
    v_mfma_f32_16x16x32_bf16 v[20:23], a[236:239], v[132:135], v[20:23]
    v_exp_f32 v153, v153
    v_mfma_f32_16x16x32_bf16 v[24:27], a[240:243], v[128:131], v[24:27]
    v_perm_b32 v148, v153, v152, s27
    v_mfma_f32_16x16x32_bf16 v[24:27], a[244:247], v[132:135], v[24:27]
    v_exp_f32 v154, v154
    v_mfma_f32_16x16x32_bf16 v[28:31], a[248:251], v[128:131], v[28:31]
    v_mfma_f32_16x16x32_bf16 v[28:31], a[252:255], v[132:135], v[28:31]
    v_exp_f32 v155, v155
    s_waitcnt vmcnt(48)
    s_barrier
    v_mfma_f32_16x16x32_bf16 v[128:131], a[64:67], a[32:35], v[168:171]
    ds_read_b128 a[64:67], v192 offset:0
    v_perm_b32 v149, v155, v154, s27
    s_add_u32 m0, s25, 0
    v_mfma_f32_16x16x32_bf16 v[128:131], a[68:71], a[36:39], v[128:131]
    buffer_load_dwordx4 v212, s[8:11], s23 offen offset:0 sc0 sc1 nt lds
    v_exp_f32 v156, v156
    v_mfma_f32_16x16x32_bf16 v[128:131], a[72:75], a[40:43], v[128:131]
    ds_read_b128 a[68:71], v193 offset:0
    v_mfma_f32_16x16x32_bf16 v[128:131], a[76:79], a[44:47], v[128:131]
    buffer_load_dwordx4 v213, s[8:11], s23 offen offset:1024 sc0 sc1 nt lds
    v_exp_f32 v157, v157
    v_mfma_f32_16x16x32_bf16 v[132:135], a[80:83], a[32:35], v[168:171]
    ds_read_b128 a[72:75], v194 offset:0
    v_perm_b32 v150, v157, v156, s27
    v_mfma_f32_16x16x32_bf16 v[132:135], a[84:87], a[36:39], v[132:135]
    v_exp_f32 v158, v158
    v_mfma_f32_16x16x32_bf16 v[132:135], a[88:91], a[40:43], v[132:135]
    ds_read_b128 a[76:79], v195 offset:0
    buffer_load_dwordx4 v212, s[8:11], s23 offen offset:2048 sc0 sc1 nt lds
    v_mfma_f32_16x16x32_bf16 v[132:135], a[92:95], a[44:47], v[132:135]
    v_exp_f32 v159, v159
    v_mfma_f32_16x16x32_bf16 v[136:139], a[96:99], a[32:35], v[168:171]
    ds_read_b128 a[80:83], v192 offset:4096
    v_perm_b32 v151, v159, v158, s27
    v_mfma_f32_16x16x32_bf16 v[136:139], a[100:103], a[36:39], v[136:139]
    ds_read_b64_tr_b16 a[128:129], v196 offset:16384
    ds_read_b64_tr_b16 a[130:131], v196 offset:20480
    buffer_load_dwordx4 v213, s[8:11], s23 offen offset:3072 sc0 sc1 nt lds
    v_mfma_f32_16x16x32_bf16 v[136:139], a[104:107], a[40:43], v[136:139]
    v_exp_f32 v128, v128
    s_add_u32 m0, s25, 4096
    v_mfma_f32_16x16x32_bf16 v[136:139], a[108:111], a[44:47], v[136:139]
    ds_read_b128 a[84:87], v193 offset:4096
    v_mfma_f32_16x16x32_bf16 v[140:143], a[112:115], a[32:35], v[168:171]
    buffer_load_dwordx4 v108, s[8:11], s23 offen offset:0 sc0 sc1 nt lds
    v_exp_f32 v129, v129
    v_mfma_f32_16x16x32_bf16 v[140:143], a[116:119], a[36:39], v[140:143]
    ds_read_b128 a[88:91], v194 offset:4096
    v_perm_b32 v128, v129, v128, s27
    v_mfma_f32_16x16x32_bf16 v[140:143], a[120:123], a[40:43], v[140:143]
    v_exp_f32 v130, v130
    v_mfma_f32_16x16x32_bf16 v[140:143], a[124:127], a[44:47], v[140:143]
    ds_read_b128 a[92:95], v195 offset:4096
    buffer_load_dwordx4 v109, s[8:11], s23 offen offset:1024 sc0 sc1 nt lds
    v_smfmac_f32_16x16x64_bf16 v[180:183], v[204:207], v[144:151], v220
    v_exp_f32 v131, v131
    v_mfma_f32_16x16x32_bf16 v[32:35], a[192:195], v[144:147], v[32:35]
    ds_read_b128 a[96:99], v192 offset:8192
    v_perm_b32 v129, v131, v130, s27
    v_mfma_f32_16x16x32_bf16 v[32:35], a[196:199], v[148:151], v[32:35]
    buffer_load_dwordx4 v108, s[8:11], s23 offen offset:2048 sc0 sc1 nt lds
    v_exp_f32 v132, v132
    v_mfma_f32_16x16x32_bf16 v[36:39], a[200:203], v[144:147], v[36:39]
    ds_read_b128 a[100:103], v193 offset:8192
    v_mfma_f32_16x16x32_bf16 v[36:39], a[204:207], v[148:151], v[36:39]
    buffer_load_dwordx4 v109, s[8:11], s23 offen offset:3072 sc0 sc1 nt lds
    v_exp_f32 v133, v133
    v_mfma_f32_16x16x32_bf16 v[40:43], a[208:211], v[144:147], v[40:43]
    ds_read_b128 a[104:107], v194 offset:8192
    v_perm_b32 v130, v133, v132, s27
    s_add_u32 m0, s25, 8192
    v_mfma_f32_16x16x32_bf16 v[40:43], a[212:215], v[148:151], v[40:43]
    v_exp_f32 v134, v134
    v_mfma_f32_16x16x32_bf16 v[44:47], a[216:219], v[144:147], v[44:47]
    ds_read_b128 a[108:111], v195 offset:8192
    buffer_load_dwordx4 v110, s[8:11], s23 offen offset:0 sc0 sc1 nt lds
    v_mfma_f32_16x16x32_bf16 v[44:47], a[220:223], v[148:151], v[44:47]
    v_exp_f32 v135, v135
    v_mfma_f32_16x16x32_bf16 v[48:51], a[224:227], v[144:147], v[48:51]
    ds_read_b128 a[112:115], v192 offset:12288
    v_perm_b32 v131, v135, v134, s27
    v_mfma_f32_16x16x32_bf16 v[48:51], a[228:231], v[148:151], v[48:51]
    buffer_load_dwordx4 v111, s[8:11], s23 offen offset:1024 sc0 sc1 nt lds
    v_exp_f32 v136, v136
    v_mfma_f32_16x16x32_bf16 v[52:55], a[232:235], v[144:147], v[52:55]
    ds_read_b128 a[116:119], v193 offset:12288
    v_mfma_f32_16x16x32_bf16 v[52:55], a[236:239], v[148:151], v[52:55]
    v_exp_f32 v137, v137
    v_mfma_f32_16x16x32_bf16 v[56:59], a[240:243], v[144:147], v[56:59]
    ds_read_b128 a[120:123], v194 offset:12288
    buffer_load_dwordx4 v110, s[8:11], s23 offen offset:2048 sc0 sc1 nt lds
    v_perm_b32 v132, v137, v136, s27
    v_mfma_f32_16x16x32_bf16 v[56:59], a[244:247], v[148:151], v[56:59]
    v_exp_f32 v138, v138
    v_mfma_f32_16x16x32_bf16 v[60:63], a[248:251], v[144:147], v[60:63]
    ds_read_b128 a[124:127], v195 offset:12288
    v_mfma_f32_16x16x32_bf16 v[60:63], a[252:255], v[148:151], v[60:63]
    v_exp_f32 v139, v139
    s_waitcnt lgkmcnt(2)
    v_mfma_f32_16x16x32_bf16 v[144:147], a[64:67], a[0:3], v[160:163]
    ds_read_b64_tr_b16 a[132:133], v196 offset:24576
    buffer_load_dwordx4 v111, s[8:11], s23 offen offset:3072 sc0 sc1 nt lds
    v_perm_b32 v133, v139, v138, s27
    v_mfma_f32_16x16x32_bf16 v[144:147], a[68:71], a[4:7], v[144:147]
    v_exp_f32 v140, v140
    s_add_u32 m0, s25, 12288
    v_mfma_f32_16x16x32_bf16 v[144:147], a[72:75], a[8:11], v[144:147]
    ds_read_b64_tr_b16 a[134:135], v196 offset:28672
    ds_read_b64_tr_b16 a[136:137], v197 offset:16384
    buffer_load_dwordx4 v112, s[8:11], s23 offen offset:0 sc0 sc1 nt lds
    v_mfma_f32_16x16x32_bf16 v[144:147], a[76:79], a[12:15], v[144:147]
    v_exp_f32 v141, v141
    v_mfma_f32_16x16x32_bf16 v[148:151], a[80:83], a[0:3], v[160:163]
    ds_read_b64_tr_b16 a[138:139], v197 offset:20480
    buffer_load_dwordx4 v113, s[8:11], s23 offen offset:1024 sc0 sc1 nt lds
    v_perm_b32 v134, v141, v140, s27
    v_mfma_f32_16x16x32_bf16 v[148:151], a[84:87], a[4:7], v[148:151]
    v_exp_f32 v142, v142
    v_mfma_f32_16x16x32_bf16 v[148:151], a[88:91], a[8:11], v[148:151]
    ds_read_b64_tr_b16 a[140:141], v197 offset:24576
    ds_read_b64_tr_b16 a[142:143], v197 offset:28672
    v_mfma_f32_16x16x32_bf16 v[148:151], a[92:95], a[12:15], v[148:151]
    buffer_load_dwordx4 v112, s[8:11], s23 offen offset:2048 sc0 sc1 nt lds
    v_exp_f32 v143, v143
    v_mfma_f32_16x16x32_bf16 v[152:155], a[96:99], a[0:3], v[160:163]
    ds_read_b64_tr_b16 a[144:145], v198 offset:16384
    v_perm_b32 v135, v143, v142, s27
    v_mfma_f32_16x16x32_bf16 v[152:155], a[100:103], a[4:7], v[152:155]
    ds_read_b64_tr_b16 a[146:147], v198 offset:20480
    ds_read_b64_tr_b16 a[148:149], v198 offset:24576
    v_mfma_f32_16x16x32_bf16 v[152:155], a[104:107], a[8:11], v[152:155]
    buffer_load_dwordx4 v113, s[8:11], s23 offen offset:3072 sc0 sc1 nt lds
    v_exp_f32 v144, v144
    s_add_u32 s23, s23, 16384
    v_mfma_f32_16x16x32_bf16 v[152:155], a[108:111], a[12:15], v[152:155]
    ds_read_b64_tr_b16 a[150:151], v198 offset:28672
    s_add_u32 s25, s24, 16384
    s_add_u32 m0, s24, 0
    s_waitcnt lgkmcnt(10)
    v_mfma_f32_16x16x32_bf16 v[156:159], a[112:115], a[0:3], v[160:163]
    v_exp_f32 v145, v145
    v_mfma_f32_16x16x32_bf16 v[156:159], a[116:119], a[4:7], v[156:159]
    ds_read_b64_tr_b16 a[152:153], v199 offset:16384
    buffer_load_dwordx4 v208, s[4:7], s22 offen offset:0 sc0 sc1 nt lds
    v_perm_b32 v144, v145, v144, s27
    v_mfma_f32_16x16x32_bf16 v[156:159], a[120:123], a[8:11], v[156:159]
    v_exp_f32 v146, v146
    v_mfma_f32_16x16x32_bf16 v[156:159], a[124:127], a[12:15], v[156:159]
    ds_read_b64_tr_b16 a[154:155], v199 offset:20480
    ds_read_b64_tr_b16 a[156:157], v199 offset:24576
    v_smfmac_f32_16x16x64_bf16 v[184:187], v[204:207], v[128:135], v220
    buffer_load_dwordx4 v209, s[4:7], s22 offen offset:1024 sc0 sc1 nt lds
    v_exp_f32 v147, v147
    v_mfma_f32_16x16x32_bf16 v[64:67], a[192:195], v[128:131], v[64:67]
    ds_read_b64_tr_b16 a[158:159], v199 offset:28672
    v_perm_b32 v145, v147, v146, s27
    v_mfma_f32_16x16x32_bf16 v[64:67], a[196:199], v[132:135], v[64:67]
    v_exp_f32 v148, v148
    v_mfma_f32_16x16x32_bf16 v[68:71], a[200:203], v[128:131], v[68:71]
    ds_read_b64_tr_b16 a[160:161], v200 offset:16384
    ds_read_b64_tr_b16 a[162:163], v200 offset:20480
    buffer_load_dwordx4 v210, s[4:7], s22 offen offset:2048 sc0 sc1 nt lds
    v_mfma_f32_16x16x32_bf16 v[68:71], a[204:207], v[132:135], v[68:71]
    v_exp_f32 v149, v149
    v_mfma_f32_16x16x32_bf16 v[72:75], a[208:211], v[128:131], v[72:75]
    ds_read_b64_tr_b16 a[164:165], v200 offset:24576
    v_perm_b32 v146, v149, v148, s27
    v_mfma_f32_16x16x32_bf16 v[72:75], a[212:215], v[132:135], v[72:75]
    buffer_load_dwordx4 v211, s[4:7], s22 offen offset:3072 sc0 sc1 nt lds
    v_exp_f32 v150, v150
    v_mfma_f32_16x16x32_bf16 v[76:79], a[216:219], v[128:131], v[76:79]
    ds_read_b64_tr_b16 a[166:167], v200 offset:28672
    ds_read_b64_tr_b16 a[168:169], v201 offset:16384
    s_add_u32 m0, s24, 4096
    v_mfma_f32_16x16x32_bf16 v[76:79], a[220:223], v[132:135], v[76:79]
    buffer_load_dwordx4 v96, s[4:7], s22 offen offset:0 sc0 sc1 nt lds
    v_exp_f32 v151, v151
    v_mfma_f32_16x16x32_bf16 v[80:83], a[224:227], v[128:131], v[80:83]
    v_perm_b32 v147, v151, v150, s27
    v_mfma_f32_16x16x32_bf16 v[80:83], a[228:231], v[132:135], v[80:83]
    v_exp_f32 v152, v152
    v_mfma_f32_16x16x32_bf16 v[84:87], a[232:235], v[128:131], v[84:87]
    ds_read_b64_tr_b16 a[170:171], v201 offset:20480
    ds_read_b64_tr_b16 a[172:173], v201 offset:24576
    buffer_load_dwordx4 v97, s[4:7], s22 offen offset:1024 sc0 sc1 nt lds
    v_mfma_f32_16x16x32_bf16 v[84:87], a[236:239], v[132:135], v[84:87]
    v_exp_f32 v153, v153
    v_mfma_f32_16x16x32_bf16 v[88:91], a[240:243], v[128:131], v[88:91]
    ds_read_b64_tr_b16 a[174:175], v201 offset:28672
    v_perm_b32 v148, v153, v152, s27
    v_mfma_f32_16x16x32_bf16 v[88:91], a[244:247], v[132:135], v[88:91]
    buffer_load_dwordx4 v98, s[4:7], s22 offen offset:2048 sc0 sc1 nt lds
    v_exp_f32 v154, v154
    v_mfma_f32_16x16x32_bf16 v[92:95], a[248:251], v[128:131], v[92:95]
    ds_read_b64_tr_b16 a[176:177], v202 offset:16384
    ds_read_b64_tr_b16 a[178:179], v202 offset:20480
    v_mfma_f32_16x16x32_bf16 v[92:95], a[252:255], v[132:135], v[92:95]
    v_exp_f32 v155, v155
    v_mfma_f32_16x16x32_bf16 v[128:131], a[64:67], a[16:19], v[164:167]
    ds_read_b64_tr_b16 a[180:181], v202 offset:24576
    buffer_load_dwordx4 v99, s[4:7], s22 offen offset:3072 sc0 sc1 nt lds
    v_perm_b32 v149, v155, v154, s27
    v_mfma_f32_16x16x32_bf16 v[128:131], a[68:71], a[20:23], v[128:131]
    v_exp_f32 v156, v156
    s_add_u32 m0, s24, 8192
    v_mfma_f32_16x16x32_bf16 v[128:131], a[72:75], a[24:27], v[128:131]
    ds_read_b64_tr_b16 a[182:183], v202 offset:28672
    ds_read_b64_tr_b16 a[184:185], v203 offset:16384
    v_mfma_f32_16x16x32_bf16 v[128:131], a[76:79], a[28:31], v[128:131]
    buffer_load_dwordx4 v100, s[4:7], s22 offen offset:0 sc0 sc1 nt lds
    v_exp_f32 v157, v157
    v_mfma_f32_16x16x32_bf16 v[132:135], a[80:83], a[16:19], v[164:167]
    ds_read_b64_tr_b16 a[186:187], v203 offset:20480
    v_perm_b32 v150, v157, v156, s27
    v_mfma_f32_16x16x32_bf16 v[132:135], a[84:87], a[20:23], v[132:135]
    v_exp_f32 v158, v158
    v_mfma_f32_16x16x32_bf16 v[132:135], a[88:91], a[24:27], v[132:135]
    ds_read_b64_tr_b16 a[188:189], v203 offset:24576
    buffer_load_dwordx4 v101, s[4:7], s22 offen offset:1024 sc0 sc1 nt lds
    v_mfma_f32_16x16x32_bf16 v[132:135], a[92:95], a[28:31], v[132:135]
    v_exp_f32 v159, v159
    v_mfma_f32_16x16x32_bf16 v[136:139], a[96:99], a[16:19], v[164:167]
    ds_read_b64_tr_b16 a[190:191], v203 offset:28672
    buffer_load_dwordx4 v102, s[4:7], s22 offen offset:2048 sc0 sc1 nt lds
    v_perm_b32 v151, v159, v158, s27
    v_mfma_f32_16x16x32_bf16 v[136:139], a[100:103], a[20:23], v[136:139]
    v_mfma_f32_16x16x32_bf16 v[136:139], a[104:107], a[24:27], v[136:139]
    v_exp_f32 v128, v128
    v_mfma_f32_16x16x32_bf16 v[136:139], a[108:111], a[28:31], v[136:139]
    buffer_load_dwordx4 v103, s[4:7], s22 offen offset:3072 sc0 sc1 nt lds
    s_add_u32 m0, s24, 12288
    v_mfma_f32_16x16x32_bf16 v[140:143], a[112:115], a[16:19], v[164:167]
    v_exp_f32 v129, v129
    v_mfma_f32_16x16x32_bf16 v[140:143], a[116:119], a[20:23], v[140:143]
    v_perm_b32 v128, v129, v128, s27
    v_mfma_f32_16x16x32_bf16 v[140:143], a[120:123], a[24:27], v[140:143]
    buffer_load_dwordx4 v104, s[4:7], s22 offen offset:0 sc0 sc1 nt lds
    v_exp_f32 v130, v130
    v_mfma_f32_16x16x32_bf16 v[140:143], a[124:127], a[28:31], v[140:143]
    s_waitcnt lgkmcnt(0)
    v_smfmac_f32_16x16x64_bf16 v[176:179], v[204:207], v[144:151], v220
    v_exp_f32 v131, v131
    v_mfma_f32_16x16x32_bf16 v[0:3], a[128:131], v[144:147], v[0:3]
    buffer_load_dwordx4 v105, s[4:7], s22 offen offset:1024 sc0 sc1 nt lds
    v_perm_b32 v129, v131, v130, s27
    v_mfma_f32_16x16x32_bf16 v[0:3], a[132:135], v[148:151], v[0:3]
    v_exp_f32 v132, v132
    v_mfma_f32_16x16x32_bf16 v[4:7], a[136:139], v[144:147], v[4:7]
    v_mfma_f32_16x16x32_bf16 v[4:7], a[140:143], v[148:151], v[4:7]
    buffer_load_dwordx4 v106, s[4:7], s22 offen offset:2048 sc0 sc1 nt lds
    v_exp_f32 v133, v133
    v_mfma_f32_16x16x32_bf16 v[8:11], a[144:147], v[144:147], v[8:11]
    v_perm_b32 v130, v133, v132, s27
    v_mfma_f32_16x16x32_bf16 v[8:11], a[148:151], v[148:151], v[8:11]
    v_exp_f32 v134, v134
    v_mfma_f32_16x16x32_bf16 v[12:15], a[152:155], v[144:147], v[12:15]
    buffer_load_dwordx4 v107, s[4:7], s22 offen offset:3072 sc0 sc1 nt lds
    s_add_u32 s22, s22, 16384
    v_mfma_f32_16x16x32_bf16 v[12:15], a[156:159], v[148:151], v[12:15]
    v_exp_f32 v135, v135
    s_add_u32 s24, s24, 32768
    v_mfma_f32_16x16x32_bf16 v[16:19], a[160:163], v[144:147], v[16:19]
    v_perm_b32 v131, v135, v134, s27
    s_and_b32 s24, s24, 0x1ffff
    v_mfma_f32_16x16x32_bf16 v[16:19], a[164:167], v[148:151], v[16:19]
    v_exp_f32 v136, v136
    v_mfma_f32_16x16x32_bf16 v[20:23], a[168:171], v[144:147], v[20:23]
    v_mfma_f32_16x16x32_bf16 v[20:23], a[172:175], v[148:151], v[20:23]
    v_exp_f32 v137, v137
    v_mfma_f32_16x16x32_bf16 v[24:27], a[176:179], v[144:147], v[24:27]
    v_perm_b32 v132, v137, v136, s27
    v_mfma_f32_16x16x32_bf16 v[24:27], a[180:183], v[148:151], v[24:27]
    v_exp_f32 v138, v138
    v_mfma_f32_16x16x32_bf16 v[28:31], a[184:187], v[144:147], v[28:31]
    v_mfma_f32_16x16x32_bf16 v[28:31], a[188:191], v[148:151], v[28:31]
    v_exp_f32 v139, v139
    s_branch L_evenB
.p2align 6
L_evenB2:
    s_waitcnt vmcnt(48)
    s_barrier
    v_mfma_f32_16x16x32_bf16 v[144:147], a[64:67], a[32:35], v[168:171]
    v_perm_b32 v133, v139, v138, s27
    ds_read_b128 a[64:67], v192 offset:32768
    s_add_u32 m0, s25, 0
    v_mfma_f32_16x16x32_bf16 v[144:147], a[68:71], a[36:39], v[144:147]
    v_exp_f32 v140, v140
    buffer_load_dwordx4 v212, s[8:11], s23 offen offset:0 sc0 sc1 nt lds
    ds_read_b128 a[68:71], v193 offset:32768
    v_mfma_f32_16x16x32_bf16 v[144:147], a[72:75], a[40:43], v[144:147]
    s_add_u32 s26, s26, 1
    v_mfma_f32_16x16x32_bf16 v[144:147], a[76:79], a[44:47], v[144:147]
    v_exp_f32 v141, v141
    buffer_load_dwordx4 v213, s[8:11], s23 offen offset:1024 sc0 sc1 nt lds
    ds_read_b128 a[72:75], v194 offset:32768
    v_mfma_f32_16x16x32_bf16 v[148:151], a[80:83], a[32:35], v[168:171]
    v_perm_b32 v134, v141, v140, s27
    v_mfma_f32_16x16x32_bf16 v[148:151], a[84:87], a[36:39], v[148:151]
    v_exp_f32 v142, v142
    ds_read_b128 a[76:79], v195 offset:32768
    v_mfma_f32_16x16x32_bf16 v[148:151], a[88:91], a[40:43], v[148:151]
    buffer_load_dwordx4 v212, s[8:11], s23 offen offset:2048 sc0 sc1 nt lds
    v_mfma_f32_16x16x32_bf16 v[148:151], a[92:95], a[44:47], v[148:151]
    v_exp_f32 v143, v143
    ds_read_b128 a[80:83], v192 offset:36864
    v_mfma_f32_16x16x32_bf16 v[152:155], a[96:99], a[32:35], v[168:171]
    v_perm_b32 v135, v143, v142, s27
    v_mfma_f32_16x16x32_bf16 v[152:155], a[100:103], a[36:39], v[152:155]
    ds_read_b64_tr_b16 a[192:193], v196 offset:49152
    ds_read_b64_tr_b16 a[194:195], v196 offset:53248
    buffer_load_dwordx4 v213, s[8:11], s23 offen offset:3072 sc0 sc1 nt lds
    v_mfma_f32_16x16x32_bf16 v[152:155], a[104:107], a[40:43], v[152:155]
    v_exp_f32 v144, v144
    s_add_u32 m0, s25, 4096
    ds_read_b128 a[84:87], v193 offset:36864
    v_mfma_f32_16x16x32_bf16 v[152:155], a[108:111], a[44:47], v[152:155]
    v_mfma_f32_16x16x32_bf16 v[156:159], a[112:115], a[32:35], v[168:171]
    v_exp_f32 v145, v145
    buffer_load_dwordx4 v108, s[8:11], s23 offen offset:0 sc0 sc1 nt lds
    ds_read_b128 a[88:91], v194 offset:36864
    v_mfma_f32_16x16x32_bf16 v[156:159], a[116:119], a[36:39], v[156:159]
    v_perm_b32 v144, v145, v144, s27
    v_mfma_f32_16x16x32_bf16 v[156:159], a[120:123], a[40:43], v[156:159]
    v_exp_f32 v146, v146
    ds_read_b128 a[92:95], v195 offset:36864
    v_mfma_f32_16x16x32_bf16 v[156:159], a[124:127], a[44:47], v[156:159]
    buffer_load_dwordx4 v109, s[8:11], s23 offen offset:1024 sc0 sc1 nt lds
    v_smfmac_f32_16x16x64_bf16 v[180:183], v[204:207], v[128:135], v220
    v_exp_f32 v147, v147
    ds_read_b128 a[96:99], v192 offset:40960
    v_mfma_f32_16x16x32_bf16 v[32:35], a[128:131], v[128:131], v[32:35]
    v_perm_b32 v145, v147, v146, s27
    v_mfma_f32_16x16x32_bf16 v[32:35], a[132:135], v[132:135], v[32:35]
    v_exp_f32 v148, v148
    buffer_load_dwordx4 v108, s[8:11], s23 offen offset:2048 sc0 sc1 nt lds
    ds_read_b128 a[100:103], v193 offset:40960
    v_mfma_f32_16x16x32_bf16 v[36:39], a[136:139], v[128:131], v[36:39]
    v_mfma_f32_16x16x32_bf16 v[36:39], a[140:143], v[132:135], v[36:39]
    v_exp_f32 v149, v149
    buffer_load_dwordx4 v109, s[8:11], s23 offen offset:3072 sc0 sc1 nt lds
    ds_read_b128 a[104:107], v194 offset:40960
    v_mfma_f32_16x16x32_bf16 v[40:43], a[144:147], v[128:131], v[40:43]
    v_perm_b32 v146, v149, v148, s27
    s_add_u32 m0, s25, 8192
    v_mfma_f32_16x16x32_bf16 v[40:43], a[148:151], v[132:135], v[40:43]
    v_exp_f32 v150, v150
    ds_read_b128 a[108:111], v195 offset:40960
    v_mfma_f32_16x16x32_bf16 v[44:47], a[152:155], v[128:131], v[44:47]
    buffer_load_dwordx4 v110, s[8:11], s23 offen offset:0 sc0 sc1 nt lds
    v_mfma_f32_16x16x32_bf16 v[44:47], a[156:159], v[132:135], v[44:47]
    v_exp_f32 v151, v151
    ds_read_b128 a[112:115], v192 offset:45056
    v_mfma_f32_16x16x32_bf16 v[48:51], a[160:163], v[128:131], v[48:51]
    v_perm_b32 v147, v151, v150, s27
    v_mfma_f32_16x16x32_bf16 v[48:51], a[164:167], v[132:135], v[48:51]
    v_exp_f32 v152, v152
    buffer_load_dwordx4 v111, s[8:11], s23 offen offset:1024 sc0 sc1 nt lds
    ds_read_b128 a[116:119], v193 offset:45056
    v_mfma_f32_16x16x32_bf16 v[52:55], a[168:171], v[128:131], v[52:55]
    v_mfma_f32_16x16x32_bf16 v[52:55], a[172:175], v[132:135], v[52:55]
    v_exp_f32 v153, v153
    ds_read_b128 a[120:123], v194 offset:45056
    v_mfma_f32_16x16x32_bf16 v[56:59], a[176:179], v[128:131], v[56:59]
    v_perm_b32 v148, v153, v152, s27
    buffer_load_dwordx4 v110, s[8:11], s23 offen offset:2048 sc0 sc1 nt lds
    v_mfma_f32_16x16x32_bf16 v[56:59], a[180:183], v[132:135], v[56:59]
    v_exp_f32 v154, v154
    ds_read_b128 a[124:127], v195 offset:45056
    v_mfma_f32_16x16x32_bf16 v[60:63], a[184:187], v[128:131], v[60:63]
    v_mfma_f32_16x16x32_bf16 v[60:63], a[188:191], v[132:135], v[60:63]
    v_exp_f32 v155, v155
    s_waitcnt lgkmcnt(2)
    v_mfma_f32_16x16x32_bf16 v[128:131], a[64:67], a[0:3], v[160:163]
    v_perm_b32 v149, v155, v154, s27
    ds_read_b64_tr_b16 a[196:197], v196 offset:57344
    buffer_load_dwordx4 v111, s[8:11], s23 offen offset:3072 sc0 sc1 nt lds
    v_mfma_f32_16x16x32_bf16 v[128:131], a[68:71], a[4:7], v[128:131]
    v_exp_f32 v156, v156
    s_add_u32 m0, s25, 12288
    ds_read_b64_tr_b16 a[198:199], v196 offset:61440
    v_mfma_f32_16x16x32_bf16 v[128:131], a[72:75], a[8:11], v[128:131]
    ds_read_b64_tr_b16 a[200:201], v197 offset:49152
    buffer_load_dwordx4 v112, s[8:11], s23 offen offset:0 sc0 sc1 nt lds
    v_mfma_f32_16x16x32_bf16 v[128:131], a[76:79], a[12:15], v[128:131]
    v_exp_f32 v157, v157
    ds_read_b64_tr_b16 a[202:203], v197 offset:53248
    v_mfma_f32_16x16x32_bf16 v[132:135], a[80:83], a[0:3], v[160:163]
    v_perm_b32 v150, v157, v156, s27
    buffer_load_dwordx4 v113, s[8:11], s23 offen offset:1024 sc0 sc1 nt lds
    v_mfma_f32_16x16x32_bf16 v[132:135], a[84:87], a[4:7], v[132:135]
    v_exp_f32 v158, v158
    ds_read_b64_tr_b16 a[204:205], v197 offset:57344
    v_mfma_f32_16x16x32_bf16 v[132:135], a[88:91], a[8:11], v[132:135]
    ds_read_b64_tr_b16 a[206:207], v197 offset:61440
    v_mfma_f32_16x16x32_bf16 v[132:135], a[92:95], a[12:15], v[132:135]
    v_exp_f32 v159, v159
    buffer_load_dwordx4 v112, s[8:11], s23 offen offset:2048 sc0 sc1 nt lds
    ds_read_b64_tr_b16 a[208:209], v198 offset:49152
    v_mfma_f32_16x16x32_bf16 v[136:139], a[96:99], a[0:3], v[160:163]
    v_perm_b32 v151, v159, v158, s27
    v_mfma_f32_16x16x32_bf16 v[136:139], a[100:103], a[4:7], v[136:139]
    ds_read_b64_tr_b16 a[210:211], v198 offset:53248
    ds_read_b64_tr_b16 a[212:213], v198 offset:57344
    v_mfma_f32_16x16x32_bf16 v[136:139], a[104:107], a[8:11], v[136:139]
    v_exp_f32 v128, v128
    buffer_load_dwordx4 v113, s[8:11], s23 offen offset:3072 sc0 sc1 nt lds
    s_add_u32 s23, s23, 16384
    ds_read_b64_tr_b16 a[214:215], v198 offset:61440
    v_mfma_f32_16x16x32_bf16 v[136:139], a[108:111], a[12:15], v[136:139]
    s_add_u32 s25, s24, 16384
    s_add_u32 m0, s24, 0
    s_waitcnt lgkmcnt(10)
    v_mfma_f32_16x16x32_bf16 v[140:143], a[112:115], a[0:3], v[160:163]
    v_exp_f32 v129, v129
    ds_read_b64_tr_b16 a[216:217], v199 offset:49152
    v_mfma_f32_16x16x32_bf16 v[140:143], a[116:119], a[4:7], v[140:143]
    v_perm_b32 v128, v129, v128, s27
    buffer_load_dwordx4 v208, s[4:7], s22 offen offset:0 sc0 sc1 nt lds
    v_mfma_f32_16x16x32_bf16 v[140:143], a[120:123], a[8:11], v[140:143]
    v_exp_f32 v130, v130
    ds_read_b64_tr_b16 a[218:219], v199 offset:53248
    v_mfma_f32_16x16x32_bf16 v[140:143], a[124:127], a[12:15], v[140:143]
    ds_read_b64_tr_b16 a[220:221], v199 offset:57344
    v_smfmac_f32_16x16x64_bf16 v[184:187], v[204:207], v[144:151], v220
    v_exp_f32 v131, v131
    buffer_load_dwordx4 v209, s[4:7], s22 offen offset:1024 sc0 sc1 nt lds
    ds_read_b64_tr_b16 a[222:223], v199 offset:61440
    v_mfma_f32_16x16x32_bf16 v[64:67], a[128:131], v[144:147], v[64:67]
    v_perm_b32 v129, v131, v130, s27
    v_mfma_f32_16x16x32_bf16 v[64:67], a[132:135], v[148:151], v[64:67]
    v_exp_f32 v132, v132
    ds_read_b64_tr_b16 a[224:225], v200 offset:49152
    v_mfma_f32_16x16x32_bf16 v[68:71], a[136:139], v[144:147], v[68:71]
    ds_read_b64_tr_b16 a[226:227], v200 offset:53248
    buffer_load_dwordx4 v210, s[4:7], s22 offen offset:2048 sc0 sc1 nt lds
    v_mfma_f32_16x16x32_bf16 v[68:71], a[140:143], v[148:151], v[68:71]
    v_exp_f32 v133, v133
    ds_read_b64_tr_b16 a[228:229], v200 offset:57344
    v_mfma_f32_16x16x32_bf16 v[72:75], a[144:147], v[144:147], v[72:75]
    v_perm_b32 v130, v133, v132, s27
    v_mfma_f32_16x16x32_bf16 v[72:75], a[148:151], v[148:151], v[72:75]
    v_exp_f32 v134, v134
    buffer_load_dwordx4 v211, s[4:7], s22 offen offset:3072 sc0 sc1 nt lds
    ds_read_b64_tr_b16 a[230:231], v200 offset:61440
    v_mfma_f32_16x16x32_bf16 v[76:79], a[152:155], v[144:147], v[76:79]
    ds_read_b64_tr_b16 a[232:233], v201 offset:49152
    s_add_u32 m0, s24, 4096
    v_mfma_f32_16x16x32_bf16 v[76:79], a[156:159], v[148:151], v[76:79]
    v_exp_f32 v135, v135
    buffer_load_dwordx4 v96, s[4:7], s22 offen offset:0 sc0 sc1 nt lds
    v_mfma_f32_16x16x32_bf16 v[80:83], a[160:163], v[144:147], v[80:83]
    v_perm_b32 v131, v135, v134, s27
    v_mfma_f32_16x16x32_bf16 v[80:83], a[164:167], v[148:151], v[80:83]
    v_exp_f32 v136, v136
    ds_read_b64_tr_b16 a[234:235], v201 offset:53248
    v_mfma_f32_16x16x32_bf16 v[84:87], a[168:171], v[144:147], v[84:87]
    ds_read_b64_tr_b16 a[236:237], v201 offset:57344
    buffer_load_dwordx4 v97, s[4:7], s22 offen offset:1024 sc0 sc1 nt lds
    v_mfma_f32_16x16x32_bf16 v[84:87], a[172:175], v[148:151], v[84:87]
    v_exp_f32 v137, v137
    ds_read_b64_tr_b16 a[238:239], v201 offset:61440
    v_mfma_f32_16x16x32_bf16 v[88:91], a[176:179], v[144:147], v[88:91]
    v_perm_b32 v132, v137, v136, s27
    v_mfma_f32_16x16x32_bf16 v[88:91], a[180:183], v[148:151], v[88:91]
    v_exp_f32 v138, v138
    buffer_load_dwordx4 v98, s[4:7], s22 offen offset:2048 sc0 sc1 nt lds
    ds_read_b64_tr_b16 a[240:241], v202 offset:49152
    v_mfma_f32_16x16x32_bf16 v[92:95], a[184:187], v[144:147], v[92:95]
    ds_read_b64_tr_b16 a[242:243], v202 offset:53248
    v_mfma_f32_16x16x32_bf16 v[92:95], a[188:191], v[148:151], v[92:95]
    v_exp_f32 v139, v139
    s_cmp_eq_u32 s26, 16
    s_cbranch_scc1 L_tailB
L_entryB2:
    v_mfma_f32_16x16x32_bf16 v[144:147], a[64:67], a[16:19], v[164:167]
    v_perm_b32 v133, v139, v138, s27
    ds_read_b64_tr_b16 a[244:245], v202 offset:57344
    buffer_load_dwordx4 v99, s[4:7], s22 offen offset:3072 sc0 sc1 nt lds
    v_mfma_f32_16x16x32_bf16 v[144:147], a[68:71], a[20:23], v[144:147]
    v_exp_f32 v140, v140
    s_add_u32 m0, s24, 8192
    ds_read_b64_tr_b16 a[246:247], v202 offset:61440
    v_mfma_f32_16x16x32_bf16 v[144:147], a[72:75], a[24:27], v[144:147]
    ds_read_b64_tr_b16 a[248:249], v203 offset:49152
    v_mfma_f32_16x16x32_bf16 v[144:147], a[76:79], a[28:31], v[144:147]
    v_exp_f32 v141, v141
    buffer_load_dwordx4 v100, s[4:7], s22 offen offset:0 sc0 sc1 nt lds
    ds_read_b64_tr_b16 a[250:251], v203 offset:53248
    v_mfma_f32_16x16x32_bf16 v[148:151], a[80:83], a[16:19], v[164:167]
    v_perm_b32 v134, v141, v140, s27
    v_mfma_f32_16x16x32_bf16 v[148:151], a[84:87], a[20:23], v[148:151]
    v_exp_f32 v142, v142
    ds_read_b64_tr_b16 a[252:253], v203 offset:57344
    v_mfma_f32_16x16x32_bf16 v[148:151], a[88:91], a[24:27], v[148:151]
    buffer_load_dwordx4 v101, s[4:7], s22 offen offset:1024 sc0 sc1 nt lds
    v_mfma_f32_16x16x32_bf16 v[148:151], a[92:95], a[28:31], v[148:151]
    v_exp_f32 v143, v143
    ds_read_b64_tr_b16 a[254:255], v203 offset:61440
    v_mfma_f32_16x16x32_bf16 v[152:155], a[96:99], a[16:19], v[164:167]
    v_perm_b32 v135, v143, v142, s27
    buffer_load_dwordx4 v102, s[4:7], s22 offen offset:2048 sc0 sc1 nt lds
    v_mfma_f32_16x16x32_bf16 v[152:155], a[100:103], a[20:23], v[152:155]
    v_xor_b32 v192, 0x10000, v192
    v_xor_b32 v193, 0x10000, v193
    v_mfma_f32_16x16x32_bf16 v[152:155], a[104:107], a[24:27], v[152:155]
    v_exp_f32 v144, v144
    v_mfma_f32_16x16x32_bf16 v[152:155], a[108:111], a[28:31], v[152:155]
    v_xor_b32 v194, 0x10000, v194
    v_xor_b32 v195, 0x10000, v195
    buffer_load_dwordx4 v103, s[4:7], s22 offen offset:3072 sc0 sc1 nt lds
    v_mfma_f32_16x16x32_bf16 v[156:159], a[112:115], a[16:19], v[164:167]
    v_exp_f32 v145, v145
    s_add_u32 m0, s24, 12288
    v_mfma_f32_16x16x32_bf16 v[156:159], a[116:119], a[20:23], v[156:159]
    v_perm_b32 v144, v145, v144, s27
    v_xor_b32 v196, 0x10000, v196
    v_mfma_f32_16x16x32_bf16 v[156:159], a[120:123], a[24:27], v[156:159]
    v_exp_f32 v146, v146
    buffer_load_dwordx4 v104, s[4:7], s22 offen offset:0 sc0 sc1 nt lds
    v_mfma_f32_16x16x32_bf16 v[156:159], a[124:127], a[28:31], v[156:159]
    v_xor_b32 v197, 0x10000, v197
    s_waitcnt lgkmcnt(0)
    v_smfmac_f32_16x16x64_bf16 v[176:179], v[204:207], v[128:135], v220
    v_exp_f32 v147, v147
    v_mfma_f32_16x16x32_bf16 v[0:3], a[192:195], v[128:131], v[0:3]
    v_perm_b32 v145, v147, v146, s27
    v_xor_b32 v198, 0x10000, v198
    buffer_load_dwordx4 v105, s[4:7], s22 offen offset:1024 sc0 sc1 nt lds
    v_mfma_f32_16x16x32_bf16 v[0:3], a[196:199], v[132:135], v[0:3]
    v_exp_f32 v148, v148
    v_mfma_f32_16x16x32_bf16 v[4:7], a[200:203], v[128:131], v[4:7]
    v_xor_b32 v199, 0x10000, v199
    v_xor_b32 v200, 0x10000, v200
    v_mfma_f32_16x16x32_bf16 v[4:7], a[204:207], v[132:135], v[4:7]
    v_exp_f32 v149, v149
    buffer_load_dwordx4 v106, s[4:7], s22 offen offset:2048 sc0 sc1 nt lds
    v_mfma_f32_16x16x32_bf16 v[8:11], a[208:211], v[128:131], v[8:11]
    v_perm_b32 v146, v149, v148, s27
    v_xor_b32 v201, 0x10000, v201
    v_mfma_f32_16x16x32_bf16 v[8:11], a[212:215], v[132:135], v[8:11]
    v_exp_f32 v150, v150
    v_mfma_f32_16x16x32_bf16 v[12:15], a[216:219], v[128:131], v[12:15]
    v_xor_b32 v202, 0x10000, v202
    v_xor_b32 v203, 0x10000, v203
    buffer_load_dwordx4 v107, s[4:7], s22 offen offset:3072 sc0 sc1 nt lds
    s_add_u32 s22, s22, 16384
    v_mfma_f32_16x16x32_bf16 v[12:15], a[220:223], v[132:135], v[12:15]
    v_exp_f32 v151, v151
    s_add_u32 s24, s24, 32768
    v_mfma_f32_16x16x32_bf16 v[16:19], a[224:227], v[128:131], v[16:19]
    v_perm_b32 v147, v151, v150, s27
    s_and_b32 s24, s24, 0x1ffff
    v_mfma_f32_16x16x32_bf16 v[16:19], a[228:231], v[132:135], v[16:19]
    v_exp_f32 v152, v152
    v_mfma_f32_16x16x32_bf16 v[20:23], a[232:235], v[128:131], v[20:23]
    v_mfma_f32_16x16x32_bf16 v[20:23], a[236:239], v[132:135], v[20:23]
    v_exp_f32 v153, v153
    v_mfma_f32_16x16x32_bf16 v[24:27], a[240:243], v[128:131], v[24:27]
    v_perm_b32 v148, v153, v152, s27
    v_mfma_f32_16x16x32_bf16 v[24:27], a[244:247], v[132:135], v[24:27]
    v_exp_f32 v154, v154
    v_mfma_f32_16x16x32_bf16 v[28:31], a[248:251], v[128:131], v[28:31]
    v_mfma_f32_16x16x32_bf16 v[28:31], a[252:255], v[132:135], v[28:31]
    v_exp_f32 v155, v155
    s_waitcnt vmcnt(48)
    s_barrier
    v_mfma_f32_16x16x32_bf16 v[128:131], a[64:67], a[32:35], v[168:171]
    v_perm_b32 v149, v155, v154, s27
    ds_read_b128 a[64:67], v192 offset:0
    s_add_u32 m0, s25, 0
    v_mfma_f32_16x16x32_bf16 v[128:131], a[68:71], a[36:39], v[128:131]
    v_exp_f32 v156, v156
    buffer_load_dwordx4 v212, s[8:11], s23 offen offset:0 sc0 sc1 nt lds
    ds_read_b128 a[68:71], v193 offset:0
    v_mfma_f32_16x16x32_bf16 v[128:131], a[72:75], a[40:43], v[128:131]
    v_mfma_f32_16x16x32_bf16 v[128:131], a[76:79], a[44:47], v[128:131]
    v_exp_f32 v157, v157
    buffer_load_dwordx4 v213, s[8:11], s23 offen offset:1024 sc0 sc1 nt lds
    ds_read_b128 a[72:75], v194 offset:0
    v_mfma_f32_16x16x32_bf16 v[132:135], a[80:83], a[32:35], v[168:171]
    v_perm_b32 v150, v157, v156, s27
    v_mfma_f32_16x16x32_bf16 v[132:135], a[84:87], a[36:39], v[132:135]
    v_exp_f32 v158, v158
    ds_read_b128 a[76:79], v195 offset:0
    v_mfma_f32_16x16x32_bf16 v[132:135], a[88:91], a[40:43], v[132:135]
    buffer_load_dwordx4 v212, s[8:11], s23 offen offset:2048 sc0 sc1 nt lds
    v_mfma_f32_16x16x32_bf16 v[132:135], a[92:95], a[44:47], v[132:135]
    v_exp_f32 v159, v159
    ds_read_b128 a[80:83], v192 offset:4096
    v_mfma_f32_16x16x32_bf16 v[136:139], a[96:99], a[32:35], v[168:171]
    v_perm_b32 v151, v159, v158, s27
    v_mfma_f32_16x16x32_bf16 v[136:139], a[100:103], a[36:39], v[136:139]
    ds_read_b64_tr_b16 a[128:129], v196 offset:16384
    ds_read_b64_tr_b16 a[130:131], v196 offset:20480
    buffer_load_dwordx4 v213, s[8:11], s23 offen offset:3072 sc0 sc1 nt lds
    v_mfma_f32_16x16x32_bf16 v[136:139], a[104:107], a[40:43], v[136:139]
    v_exp_f32 v128, v128
    s_add_u32 m0, s25, 4096
    ds_read_b128 a[84:87], v193 offset:4096
    v_mfma_f32_16x16x32_bf16 v[136:139], a[108:111], a[44:47], v[136:139]
    v_mfma_f32_16x16x32_bf16 v[140:143], a[112:115], a[32:35], v[168:171]
    v_exp_f32 v129, v129
    buffer_load_dwordx4 v108, s[8:11], s23 offen offset:0 sc0 sc1 nt lds
    ds_read_b128 a[88:91], v194 offset:4096
    v_mfma_f32_16x16x32_bf16 v[140:143], a[116:119], a[36:39], v[140:143]
    v_perm_b32 v128, v129, v128, s27
    v_mfma_f32_16x16x32_bf16 v[140:143], a[120:123], a[40:43], v[140:143]
    v_exp_f32 v130, v130
    ds_read_b128 a[92:95], v195 offset:4096
    v_mfma_f32_16x16x32_bf16 v[140:143], a[124:127], a[44:47], v[140:143]
    buffer_load_dwordx4 v109, s[8:11], s23 offen offset:1024 sc0 sc1 nt lds
    v_smfmac_f32_16x16x64_bf16 v[180:183], v[204:207], v[144:151], v220
    v_exp_f32 v131, v131
    ds_read_b128 a[96:99], v192 offset:8192
    v_mfma_f32_16x16x32_bf16 v[32:35], a[192:195], v[144:147], v[32:35]
    v_perm_b32 v129, v131, v130, s27
    v_mfma_f32_16x16x32_bf16 v[32:35], a[196:199], v[148:151], v[32:35]
    v_exp_f32 v132, v132
    buffer_load_dwordx4 v108, s[8:11], s23 offen offset:2048 sc0 sc1 nt lds
    ds_read_b128 a[100:103], v193 offset:8192
    v_mfma_f32_16x16x32_bf16 v[36:39], a[200:203], v[144:147], v[36:39]
    v_mfma_f32_16x16x32_bf16 v[36:39], a[204:207], v[148:151], v[36:39]
    v_exp_f32 v133, v133
    buffer_load_dwordx4 v109, s[8:11], s23 offen offset:3072 sc0 sc1 nt lds
    ds_read_b128 a[104:107], v194 offset:8192
    v_mfma_f32_16x16x32_bf16 v[40:43], a[208:211], v[144:147], v[40:43]
    v_perm_b32 v130, v133, v132, s27
    s_add_u32 m0, s25, 8192
    v_mfma_f32_16x16x32_bf16 v[40:43], a[212:215], v[148:151], v[40:43]
    v_exp_f32 v134, v134
    ds_read_b128 a[108:111], v195 offset:8192
    v_mfma_f32_16x16x32_bf16 v[44:47], a[216:219], v[144:147], v[44:47]
    buffer_load_dwordx4 v110, s[8:11], s23 offen offset:0 sc0 sc1 nt lds
    v_mfma_f32_16x16x32_bf16 v[44:47], a[220:223], v[148:151], v[44:47]
    v_exp_f32 v135, v135
    ds_read_b128 a[112:115], v192 offset:12288
    v_mfma_f32_16x16x32_bf16 v[48:51], a[224:227], v[144:147], v[48:51]
    v_perm_b32 v131, v135, v134, s27
    v_mfma_f32_16x16x32_bf16 v[48:51], a[228:231], v[148:151], v[48:51]
    v_exp_f32 v136, v136
    buffer_load_dwordx4 v111, s[8:11], s23 offen offset:1024 sc0 sc1 nt lds
    ds_read_b128 a[116:119], v193 offset:12288
    v_mfma_f32_16x16x32_bf16 v[52:55], a[232:235], v[144:147], v[52:55]
    v_mfma_f32_16x16x32_bf16 v[52:55], a[236:239], v[148:151], v[52:55]
    v_exp_f32 v137, v137
    ds_read_b128 a[120:123], v194 offset:12288
    v_mfma_f32_16x16x32_bf16 v[56:59], a[240:243], v[144:147], v[56:59]
    v_perm_b32 v132, v137, v136, s27
    buffer_load_dwordx4 v110, s[8:11], s23 offen offset:2048 sc0 sc1 nt lds
    v_mfma_f32_16x16x32_bf16 v[56:59], a[244:247], v[148:151], v[56:59]
    v_exp_f32 v138, v138
    ds_read_b128 a[124:127], v195 offset:12288
    v_mfma_f32_16x16x32_bf16 v[60:63], a[248:251], v[144:147], v[60:63]
    v_mfma_f32_16x16x32_bf16 v[60:63], a[252:255], v[148:151], v[60:63]
    v_exp_f32 v139, v139
    s_waitcnt lgkmcnt(2)
    v_mfma_f32_16x16x32_bf16 v[144:147], a[64:67], a[0:3], v[160:163]
    v_perm_b32 v133, v139, v138, s27
    ds_read_b64_tr_b16 a[132:133], v196 offset:24576
    buffer_load_dwordx4 v111, s[8:11], s23 offen offset:3072 sc0 sc1 nt lds
    v_mfma_f32_16x16x32_bf16 v[144:147], a[68:71], a[4:7], v[144:147]
    v_exp_f32 v140, v140
    s_add_u32 m0, s25, 12288
    ds_read_b64_tr_b16 a[134:135], v196 offset:28672
    v_mfma_f32_16x16x32_bf16 v[144:147], a[72:75], a[8:11], v[144:147]
    ds_read_b64_tr_b16 a[136:137], v197 offset:16384
    buffer_load_dwordx4 v112, s[8:11], s23 offen offset:0 sc0 sc1 nt lds
    v_mfma_f32_16x16x32_bf16 v[144:147], a[76:79], a[12:15], v[144:147]
    v_exp_f32 v141, v141
    ds_read_b64_tr_b16 a[138:139], v197 offset:20480
    v_mfma_f32_16x16x32_bf16 v[148:151], a[80:83], a[0:3], v[160:163]
    v_perm_b32 v134, v141, v140, s27
    buffer_load_dwordx4 v113, s[8:11], s23 offen offset:1024 sc0 sc1 nt lds
    v_mfma_f32_16x16x32_bf16 v[148:151], a[84:87], a[4:7], v[148:151]
    v_exp_f32 v142, v142
    ds_read_b64_tr_b16 a[140:141], v197 offset:24576
    v_mfma_f32_16x16x32_bf16 v[148:151], a[88:91], a[8:11], v[148:151]
    ds_read_b64_tr_b16 a[142:143], v197 offset:28672
    v_mfma_f32_16x16x32_bf16 v[148:151], a[92:95], a[12:15], v[148:151]
    v_exp_f32 v143, v143
    buffer_load_dwordx4 v112, s[8:11], s23 offen offset:2048 sc0 sc1 nt lds
    ds_read_b64_tr_b16 a[144:145], v198 offset:16384
    v_mfma_f32_16x16x32_bf16 v[152:155], a[96:99], a[0:3], v[160:163]
    v_perm_b32 v135, v143, v142, s27
    v_mfma_f32_16x16x32_bf16 v[152:155], a[100:103], a[4:7], v[152:155]
    ds_read_b64_tr_b16 a[146:147], v198 offset:20480
    ds_read_b64_tr_b16 a[148:149], v198 offset:24576
    v_mfma_f32_16x16x32_bf16 v[152:155], a[104:107], a[8:11], v[152:155]
    v_exp_f32 v144, v144
    buffer_load_dwordx4 v113, s[8:11], s23 offen offset:3072 sc0 sc1 nt lds
    s_add_u32 s23, s23, 16384
    ds_read_b64_tr_b16 a[150:151], v198 offset:28672
    v_mfma_f32_16x16x32_bf16 v[152:155], a[108:111], a[12:15], v[152:155]
    s_add_u32 s25, s24, 16384
    s_add_u32 m0, s24, 0
    s_waitcnt lgkmcnt(10)
    v_mfma_f32_16x16x32_bf16 v[156:159], a[112:115], a[0:3], v[160:163]
    v_exp_f32 v145, v145
    ds_read_b64_tr_b16 a[152:153], v199 offset:16384
    v_mfma_f32_16x16x32_bf16 v[156:159], a[116:119], a[4:7], v[156:159]
    v_perm_b32 v144, v145, v144, s27
    buffer_load_dwordx4 v208, s[4:7], s22 offen offset:0 sc0 sc1 nt lds
    v_mfma_f32_16x16x32_bf16 v[156:159], a[120:123], a[8:11], v[156:159]
    v_exp_f32 v146, v146
    ds_read_b64_tr_b16 a[154:155], v199 offset:20480
    v_mfma_f32_16x16x32_bf16 v[156:159], a[124:127], a[12:15], v[156:159]
    ds_read_b64_tr_b16 a[156:157], v199 offset:24576
    v_smfmac_f32_16x16x64_bf16 v[184:187], v[204:207], v[128:135], v220
    v_exp_f32 v147, v147
    buffer_load_dwordx4 v209, s[4:7], s22 offen offset:1024 sc0 sc1 nt lds
    ds_read_b64_tr_b16 a[158:159], v199 offset:28672
    v_mfma_f32_16x16x32_bf16 v[64:67], a[192:195], v[128:131], v[64:67]
    v_perm_b32 v145, v147, v146, s27
    v_mfma_f32_16x16x32_bf16 v[64:67], a[196:199], v[132:135], v[64:67]
    v_exp_f32 v148, v148
    ds_read_b64_tr_b16 a[160:161], v200 offset:16384
    v_mfma_f32_16x16x32_bf16 v[68:71], a[200:203], v[128:131], v[68:71]
    ds_read_b64_tr_b16 a[162:163], v200 offset:20480
    buffer_load_dwordx4 v210, s[4:7], s22 offen offset:2048 sc0 sc1 nt lds
    v_mfma_f32_16x16x32_bf16 v[68:71], a[204:207], v[132:135], v[68:71]
    v_exp_f32 v149, v149
    ds_read_b64_tr_b16 a[164:165], v200 offset:24576
    v_mfma_f32_16x16x32_bf16 v[72:75], a[208:211], v[128:131], v[72:75]
    v_perm_b32 v146, v149, v148, s27
    v_mfma_f32_16x16x32_bf16 v[72:75], a[212:215], v[132:135], v[72:75]
    v_exp_f32 v150, v150
    buffer_load_dwordx4 v211, s[4:7], s22 offen offset:3072 sc0 sc1 nt lds
    ds_read_b64_tr_b16 a[166:167], v200 offset:28672
    v_mfma_f32_16x16x32_bf16 v[76:79], a[216:219], v[128:131], v[76:79]
    ds_read_b64_tr_b16 a[168:169], v201 offset:16384
    s_add_u32 m0, s24, 4096
    v_mfma_f32_16x16x32_bf16 v[76:79], a[220:223], v[132:135], v[76:79]
    v_exp_f32 v151, v151
    buffer_load_dwordx4 v96, s[4:7], s22 offen offset:0 sc0 sc1 nt lds
    v_mfma_f32_16x16x32_bf16 v[80:83], a[224:227], v[128:131], v[80:83]
    v_perm_b32 v147, v151, v150, s27
    v_mfma_f32_16x16x32_bf16 v[80:83], a[228:231], v[132:135], v[80:83]
    v_exp_f32 v152, v152
    ds_read_b64_tr_b16 a[170:171], v201 offset:20480
    v_mfma_f32_16x16x32_bf16 v[84:87], a[232:235], v[128:131], v[84:87]
    ds_read_b64_tr_b16 a[172:173], v201 offset:24576
    buffer_load_dwordx4 v97, s[4:7], s22 offen offset:1024 sc0 sc1 nt lds
    v_mfma_f32_16x16x32_bf16 v[84:87], a[236:239], v[132:135], v[84:87]
    v_exp_f32 v153, v153
    ds_read_b64_tr_b16 a[174:175], v201 offset:28672
    v_mfma_f32_16x16x32_bf16 v[88:91], a[240:243], v[128:131], v[88:91]
    v_perm_b32 v148, v153, v152, s27
    v_mfma_f32_16x16x32_bf16 v[88:91], a[244:247], v[132:135], v[88:91]
    v_exp_f32 v154, v154
    buffer_load_dwordx4 v98, s[4:7], s22 offen offset:2048 sc0 sc1 nt lds
    ds_read_b64_tr_b16 a[176:177], v202 offset:16384
    v_mfma_f32_16x16x32_bf16 v[92:95], a[248:251], v[128:131], v[92:95]
    ds_read_b64_tr_b16 a[178:179], v202 offset:20480
    v_mfma_f32_16x16x32_bf16 v[92:95], a[252:255], v[132:135], v[92:95]
    v_exp_f32 v155, v155
    v_mfma_f32_16x16x32_bf16 v[128:131], a[64:67], a[16:19], v[164:167]
    v_perm_b32 v149, v155, v154, s27
    ds_read_b64_tr_b16 a[180:181], v202 offset:24576
    buffer_load_dwordx4 v99, s[4:7], s22 offen offset:3072 sc0 sc1 nt lds
    v_mfma_f32_16x16x32_bf16 v[128:131], a[68:71], a[20:23], v[128:131]
    v_exp_f32 v156, v156
    s_add_u32 m0, s24, 8192
    ds_read_b64_tr_b16 a[182:183], v202 offset:28672
    v_mfma_f32_16x16x32_bf16 v[128:131], a[72:75], a[24:27], v[128:131]
    ds_read_b64_tr_b16 a[184:185], v203 offset:16384
    v_mfma_f32_16x16x32_bf16 v[128:131], a[76:79], a[28:31], v[128:131]
    v_exp_f32 v157, v157
    buffer_load_dwordx4 v100, s[4:7], s22 offen offset:0 sc0 sc1 nt lds
    ds_read_b64_tr_b16 a[186:187], v203 offset:20480
    v_mfma_f32_16x16x32_bf16 v[132:135], a[80:83], a[16:19], v[164:167]
    v_perm_b32 v150, v157, v156, s27
    v_mfma_f32_16x16x32_bf16 v[132:135], a[84:87], a[20:23], v[132:135]
    v_exp_f32 v158, v158
    ds_read_b64_tr_b16 a[188:189], v203 offset:24576
    v_mfma_f32_16x16x32_bf16 v[132:135], a[88:91], a[24:27], v[132:135]
    buffer_load_dwordx4 v101, s[4:7], s22 offen offset:1024 sc0 sc1 nt lds
    v_mfma_f32_16x16x32_bf16 v[132:135], a[92:95], a[28:31], v[132:135]
    v_exp_f32 v159, v159
    ds_read_b64_tr_b16 a[190:191], v203 offset:28672
    v_mfma_f32_16x16x32_bf16 v[136:139], a[96:99], a[16:19], v[164:167]
    v_perm_b32 v151, v159, v158, s27
    buffer_load_dwordx4 v102, s[4:7], s22 offen offset:2048 sc0 sc1 nt lds
    v_mfma_f32_16x16x32_bf16 v[136:139], a[100:103], a[20:23], v[136:139]
    v_mfma_f32_16x16x32_bf16 v[136:139], a[104:107], a[24:27], v[136:139]
    v_exp_f32 v128, v128
    v_mfma_f32_16x16x32_bf16 v[136:139], a[108:111], a[28:31], v[136:139]
    buffer_load_dwordx4 v103, s[4:7], s22 offen offset:3072 sc0 sc1 nt lds
    s_add_u32 m0, s24, 12288
    v_mfma_f32_16x16x32_bf16 v[140:143], a[112:115], a[16:19], v[164:167]
    v_exp_f32 v129, v129
    v_mfma_f32_16x16x32_bf16 v[140:143], a[116:119], a[20:23], v[140:143]
    v_perm_b32 v128, v129, v128, s27
    v_mfma_f32_16x16x32_bf16 v[140:143], a[120:123], a[24:27], v[140:143]
    v_exp_f32 v130, v130
    buffer_load_dwordx4 v104, s[4:7], s22 offen offset:0 sc0 sc1 nt lds
    v_mfma_f32_16x16x32_bf16 v[140:143], a[124:127], a[28:31], v[140:143]
    s_waitcnt lgkmcnt(0)
    v_smfmac_f32_16x16x64_bf16 v[176:179], v[204:207], v[144:151], v220
    v_exp_f32 v131, v131
    v_mfma_f32_16x16x32_bf16 v[0:3], a[128:131], v[144:147], v[0:3]
    v_perm_b32 v129, v131, v130, s27
    buffer_load_dwordx4 v105, s[4:7], s22 offen offset:1024 sc0 sc1 nt lds
    v_mfma_f32_16x16x32_bf16 v[0:3], a[132:135], v[148:151], v[0:3]
    v_exp_f32 v132, v132
    v_mfma_f32_16x16x32_bf16 v[4:7], a[136:139], v[144:147], v[4:7]
    v_mfma_f32_16x16x32_bf16 v[4:7], a[140:143], v[148:151], v[4:7]
    v_exp_f32 v133, v133
    buffer_load_dwordx4 v106, s[4:7], s22 offen offset:2048 sc0 sc1 nt lds
    v_mfma_f32_16x16x32_bf16 v[8:11], a[144:147], v[144:147], v[8:11]
    v_perm_b32 v130, v133, v132, s27
    v_mfma_f32_16x16x32_bf16 v[8:11], a[148:151], v[148:151], v[8:11]
    v_exp_f32 v134, v134
    v_mfma_f32_16x16x32_bf16 v[12:15], a[152:155], v[144:147], v[12:15]
    buffer_load_dwordx4 v107, s[4:7], s22 offen offset:3072 sc0 sc1 nt lds
    s_add_u32 s22, s22, 16384
    v_mfma_f32_16x16x32_bf16 v[12:15], a[156:159], v[148:151], v[12:15]
    v_exp_f32 v135, v135
    s_add_u32 s24, s24, 32768
    v_mfma_f32_16x16x32_bf16 v[16:19], a[160:163], v[144:147], v[16:19]
    v_perm_b32 v131, v135, v134, s27
    s_and_b32 s24, s24, 0x1ffff
    v_mfma_f32_16x16x32_bf16 v[16:19], a[164:167], v[148:151], v[16:19]
    v_exp_f32 v136, v136
    v_mfma_f32_16x16x32_bf16 v[20:23], a[168:171], v[144:147], v[20:23]
    v_mfma_f32_16x16x32_bf16 v[20:23], a[172:175], v[148:151], v[20:23]
    v_exp_f32 v137, v137
    v_mfma_f32_16x16x32_bf16 v[24:27], a[176:179], v[144:147], v[24:27]
    v_perm_b32 v132, v137, v136, s27
    v_mfma_f32_16x16x32_bf16 v[24:27], a[180:183], v[148:151], v[24:27]
    v_exp_f32 v138, v138
    v_mfma_f32_16x16x32_bf16 v[28:31], a[184:187], v[144:147], v[28:31]
    v_mfma_f32_16x16x32_bf16 v[28:31], a[188:191], v[148:151], v[28:31]
    v_exp_f32 v139, v139
    s_cmp_lt_u32 s26, s66
    s_cbranch_scc1 L_evenB2
    s_branch L_evenB
.p2align 6
L_evenB3:
    s_waitcnt vmcnt(48)
    s_barrier
    v_mfma_f32_16x16x32_bf16 v[144:147], a[64:67], a[32:35], v[168:171]
    v_perm_b32 v133, v139, v138, s27
    ds_read_b128 a[64:67], v192 offset:32768
    s_add_u32 m0, s25, 0
    v_mfma_f32_16x16x32_bf16 v[144:147], a[68:71], a[36:39], v[144:147]
    v_exp_f32 v140, v140
    buffer_load_dwordx4 v212, s[8:11], s23 offen offset:0 sc0 sc1 nt lds
    ds_read_b128 a[68:71], v193 offset:32768
    v_mfma_f32_16x16x32_bf16 v[144:147], a[72:75], a[40:43], v[144:147]
    s_add_u32 s26, s26, 1
    v_mfma_f32_16x16x32_bf16 v[144:147], a[76:79], a[44:47], v[144:147]
    v_exp_f32 v141, v141
    buffer_load_dwordx4 v213, s[8:11], s23 offen offset:1024 sc0 sc1 nt lds
    ds_read_b128 a[72:75], v194 offset:32768
    v_mfma_f32_16x16x32_bf16 v[148:151], a[80:83], a[32:35], v[168:171]
    v_perm_b32 v134, v141, v140, s27
    v_mfma_f32_16x16x32_bf16 v[148:151], a[84:87], a[36:39], v[148:151]
    v_exp_f32 v142, v142
    ds_read_b128 a[76:79], v195 offset:32768
    v_mfma_f32_16x16x32_bf16 v[148:151], a[88:91], a[40:43], v[148:151]
    buffer_load_dwordx4 v212, s[8:11], s23 offen offset:2048 sc0 sc1 nt lds
    v_mfma_f32_16x16x32_bf16 v[148:151], a[92:95], a[44:47], v[148:151]
    v_exp_f32 v143, v143
    ds_read_b128 a[80:83], v192 offset:36864
    v_mfma_f32_16x16x32_bf16 v[152:155], a[96:99], a[32:35], v[168:171]
    v_perm_b32 v135, v143, v142, s27
    v_mfma_f32_16x16x32_bf16 v[152:155], a[100:103], a[36:39], v[152:155]
    ds_read_b64_tr_b16 a[192:193], v196 offset:49152
    ds_read_b64_tr_b16 a[194:195], v196 offset:53248
    buffer_load_dwordx4 v213, s[8:11], s23 offen offset:3072 sc0 sc1 nt lds
    v_mfma_f32_16x16x32_bf16 v[152:155], a[104:107], a[40:43], v[152:155]
    v_exp_f32 v144, v144
    s_add_u32 m0, s25, 4096
    ds_read_b128 a[84:87], v193 offset:36864
    v_mfma_f32_16x16x32_bf16 v[152:155], a[108:111], a[44:47], v[152:155]
    v_mfma_f32_16x16x32_bf16 v[156:159], a[112:115], a[32:35], v[168:171]
    v_exp_f32 v145, v145
    buffer_load_dwordx4 v108, s[8:11], s23 offen offset:0 sc0 sc1 nt lds
    ds_read_b128 a[88:91], v194 offset:36864
    v_mfma_f32_16x16x32_bf16 v[156:159], a[116:119], a[36:39], v[156:159]
    v_perm_b32 v144, v145, v144, s27
    v_mfma_f32_16x16x32_bf16 v[156:159], a[120:123], a[40:43], v[156:159]
    v_exp_f32 v146, v146
    ds_read_b128 a[92:95], v195 offset:36864
    s_waitcnt lgkmcnt(0)
    v_mfma_f32_16x16x32_bf16 v[156:159], a[124:127], a[44:47], v[156:159]
    buffer_load_dwordx4 v109, s[8:11], s23 offen offset:1024 sc0 sc1 nt lds
    v_smfmac_f32_16x16x64_bf16 v[180:183], v[204:207], v[128:135], v220
    v_exp_f32 v147, v147
    ds_read_b128 a[96:99], v192 offset:40960
    v_mfma_f32_16x16x32_bf16 v[32:35], a[128:131], v[128:131], v[32:35]
    v_perm_b32 v145, v147, v146, s27
    v_mfma_f32_16x16x32_bf16 v[32:35], a[132:135], v[132:135], v[32:35]
    v_exp_f32 v148, v148
    buffer_load_dwordx4 v108, s[8:11], s23 offen offset:2048 sc0 sc1 nt lds
    ds_read_b128 a[100:103], v193 offset:40960
    v_mfma_f32_16x16x32_bf16 v[36:39], a[136:139], v[128:131], v[36:39]
    v_mfma_f32_16x16x32_bf16 v[36:39], a[140:143], v[132:135], v[36:39]
    v_exp_f32 v149, v149
    buffer_load_dwordx4 v109, s[8:11], s23 offen offset:3072 sc0 sc1 nt lds
    ds_read_b128 a[104:107], v194 offset:40960
    v_mfma_f32_16x16x32_bf16 v[40:43], a[144:147], v[128:131], v[40:43]
    v_perm_b32 v146, v149, v148, s27
    s_add_u32 m0, s25, 8192
    v_mfma_f32_16x16x32_bf16 v[40:43], a[148:151], v[132:135], v[40:43]
    v_exp_f32 v150, v150
    ds_read_b128 a[108:111], v195 offset:40960
    v_mfma_f32_16x16x32_bf16 v[44:47], a[152:155], v[128:131], v[44:47]
    buffer_load_dwordx4 v110, s[8:11], s23 offen offset:0 sc0 sc1 nt lds
    v_mfma_f32_16x16x32_bf16 v[44:47], a[156:159], v[132:135], v[44:47]
    v_exp_f32 v151, v151
    ds_read_b128 a[112:115], v192 offset:45056
    v_mfma_f32_16x16x32_bf16 v[48:51], a[160:163], v[128:131], v[48:51]
    v_perm_b32 v147, v151, v150, s27
    v_mfma_f32_16x16x32_bf16 v[48:51], a[164:167], v[132:135], v[48:51]
    v_exp_f32 v152, v152
    buffer_load_dwordx4 v111, s[8:11], s23 offen offset:1024 sc0 sc1 nt lds
    ds_read_b128 a[116:119], v193 offset:45056
    v_mfma_f32_16x16x32_bf16 v[52:55], a[168:171], v[128:131], v[52:55]
    v_mfma_f32_16x16x32_bf16 v[52:55], a[172:175], v[132:135], v[52:55]
    v_exp_f32 v153, v153
    ds_read_b128 a[120:123], v194 offset:45056
    v_mfma_f32_16x16x32_bf16 v[56:59], a[176:179], v[128:131], v[56:59]
    v_perm_b32 v148, v153, v152, s27
    buffer_load_dwordx4 v110, s[8:11], s23 offen offset:2048 sc0 sc1 nt lds
    v_mfma_f32_16x16x32_bf16 v[56:59], a[180:183], v[132:135], v[56:59]
    v_exp_f32 v154, v154
    ds_read_b128 a[124:127], v195 offset:45056
    s_waitcnt lgkmcnt(0)
    v_mfma_f32_16x16x32_bf16 v[60:63], a[184:187], v[128:131], v[60:63]
    v_mfma_f32_16x16x32_bf16 v[60:63], a[188:191], v[132:135], v[60:63]
    v_exp_f32 v155, v155
    v_mfma_f32_16x16x32_bf16 v[128:131], a[64:67], a[0:3], v[160:163]
    v_perm_b32 v149, v155, v154, s27
    ds_read_b64_tr_b16 a[196:197], v196 offset:57344
    buffer_load_dwordx4 v111, s[8:11], s23 offen offset:3072 sc0 sc1 nt lds
    v_mfma_f32_16x16x32_bf16 v[128:131], a[68:71], a[4:7], v[128:131]
    v_exp_f32 v156, v156
    s_add_u32 m0, s25, 12288
    ds_read_b64_tr_b16 a[198:199], v196 offset:61440
    v_mfma_f32_16x16x32_bf16 v[128:131], a[72:75], a[8:11], v[128:131]
    ds_read_b64_tr_b16 a[200:201], v197 offset:49152
    buffer_load_dwordx4 v112, s[8:11], s23 offen offset:0 sc0 sc1 nt lds
    v_mfma_f32_16x16x32_bf16 v[128:131], a[76:79], a[12:15], v[128:131]
    v_exp_f32 v157, v157
    ds_read_b64_tr_b16 a[202:203], v197 offset:53248
    v_mfma_f32_16x16x32_bf16 v[132:135], a[80:83], a[0:3], v[160:163]
    v_perm_b32 v150, v157, v156, s27
    buffer_load_dwordx4 v113, s[8:11], s23 offen offset:1024 sc0 sc1 nt lds
    v_mfma_f32_16x16x32_bf16 v[132:135], a[84:87], a[4:7], v[132:135]
    v_exp_f32 v158, v158
    ds_read_b64_tr_b16 a[204:205], v197 offset:57344
    v_mfma_f32_16x16x32_bf16 v[132:135], a[88:91], a[8:11], v[132:135]
    ds_read_b64_tr_b16 a[206:207], v197 offset:61440
    v_mfma_f32_16x16x32_bf16 v[132:135], a[92:95], a[12:15], v[132:135]
    v_exp_f32 v159, v159
    buffer_load_dwordx4 v112, s[8:11], s23 offen offset:2048 sc0 sc1 nt lds
    ds_read_b64_tr_b16 a[208:209], v198 offset:49152
    v_mfma_f32_16x16x32_bf16 v[136:139], a[96:99], a[0:3], v[160:163]
    v_perm_b32 v151, v159, v158, s27
    v_mfma_f32_16x16x32_bf16 v[136:139], a[100:103], a[4:7], v[136:139]
    ds_read_b64_tr_b16 a[210:211], v198 offset:53248
    ds_read_b64_tr_b16 a[212:213], v198 offset:57344
    v_mfma_f32_16x16x32_bf16 v[136:139], a[104:107], a[8:11], v[136:139]
    v_exp_f32 v128, v128
    buffer_load_dwordx4 v113, s[8:11], s23 offen offset:3072 sc0 sc1 nt lds
    s_add_u32 s23, s23, 16384
    ds_read_b64_tr_b16 a[214:215], v198 offset:61440
    v_mfma_f32_16x16x32_bf16 v[136:139], a[108:111], a[12:15], v[136:139]
    s_add_u32 s25, s24, 16384
    s_add_u32 m0, s24, 0
    v_mfma_f32_16x16x32_bf16 v[140:143], a[112:115], a[0:3], v[160:163]
    v_exp_f32 v129, v129
    ds_read_b64_tr_b16 a[216:217], v199 offset:49152
    v_mfma_f32_16x16x32_bf16 v[140:143], a[116:119], a[4:7], v[140:143]
    v_perm_b32 v128, v129, v128, s27
    buffer_load_dwordx4 v208, s[4:7], s22 offen offset:0 sc0 sc1 nt lds
    v_mfma_f32_16x16x32_bf16 v[140:143], a[120:123], a[8:11], v[140:143]
    v_exp_f32 v130, v130
    ds_read_b64_tr_b16 a[218:219], v199 offset:53248
    v_mfma_f32_16x16x32_bf16 v[140:143], a[124:127], a[12:15], v[140:143]
    ds_read_b64_tr_b16 a[220:221], v199 offset:57344
    v_smfmac_f32_16x16x64_bf16 v[184:187], v[204:207], v[144:151], v220
    v_exp_f32 v131, v131
    buffer_load_dwordx4 v209, s[4:7], s22 offen offset:1024 sc0 sc1 nt lds
    ds_read_b64_tr_b16 a[222:223], v199 offset:61440
    v_mfma_f32_16x16x32_bf16 v[64:67], a[128:131], v[144:147], v[64:67]
    v_perm_b32 v129, v131, v130, s27
    v_mfma_f32_16x16x32_bf16 v[64:67], a[132:135], v[148:151], v[64:67]
    v_exp_f32 v132, v132
    ds_read_b64_tr_b16 a[224:225], v200 offset:49152
    v_mfma_f32_16x16x32_bf16 v[68:71], a[136:139], v[144:147], v[68:71]
    ds_read_b64_tr_b16 a[226:227], v200 offset:53248
    buffer_load_dwordx4 v210, s[4:7], s22 offen offset:2048 sc0 sc1 nt lds
    v_mfma_f32_16x16x32_bf16 v[68:71], a[140:143], v[148:151], v[68:71]
    v_exp_f32 v133, v133
    ds_read_b64_tr_b16 a[228:229], v200 offset:57344
    v_mfma_f32_16x16x32_bf16 v[72:75], a[144:147], v[144:147], v[72:75]
    v_perm_b32 v130, v133, v132, s27
    v_mfma_f32_16x16x32_bf16 v[72:75], a[148:151], v[148:151], v[72:75]
    v_exp_f32 v134, v134
    buffer_load_dwordx4 v211, s[4:7], s22 offen offset:3072 sc0 sc1 nt lds
    ds_read_b64_tr_b16 a[230:231], v200 offset:61440
    v_mfma_f32_16x16x32_bf16 v[76:79], a[152:155], v[144:147], v[76:79]
    ds_read_b64_tr_b16 a[232:233], v201 offset:49152
    s_add_u32 m0, s24, 4096
    v_mfma_f32_16x16x32_bf16 v[76:79], a[156:159], v[148:151], v[76:79]
    v_exp_f32 v135, v135
    buffer_load_dwordx4 v96, s[4:7], s22 offen offset:0 sc0 sc1 nt lds
    v_mfma_f32_16x16x32_bf16 v[80:83], a[160:163], v[144:147], v[80:83]
    v_perm_b32 v131, v135, v134, s27
    v_mfma_f32_16x16x32_bf16 v[80:83], a[164:167], v[148:151], v[80:83]
    v_exp_f32 v136, v136
    ds_read_b64_tr_b16 a[234:235], v201 offset:53248
    v_mfma_f32_16x16x32_bf16 v[84:87], a[168:171], v[144:147], v[84:87]
    ds_read_b64_tr_b16 a[236:237], v201 offset:57344
    buffer_load_dwordx4 v97, s[4:7], s22 offen offset:1024 sc0 sc1 nt lds
    v_mfma_f32_16x16x32_bf16 v[84:87], a[172:175], v[148:151], v[84:87]
    v_exp_f32 v137, v137
    ds_read_b64_tr_b16 a[238:239], v201 offset:61440
    v_mfma_f32_16x16x32_bf16 v[88:91], a[176:179], v[144:147], v[88:91]
    v_perm_b32 v132, v137, v136, s27
    v_mfma_f32_16x16x32_bf16 v[88:91], a[180:183], v[148:151], v[88:91]
    v_exp_f32 v138, v138
    buffer_load_dwordx4 v98, s[4:7], s22 offen offset:2048 sc0 sc1 nt lds
    ds_read_b64_tr_b16 a[240:241], v202 offset:49152
    v_mfma_f32_16x16x32_bf16 v[92:95], a[184:187], v[144:147], v[92:95]
    ds_read_b64_tr_b16 a[242:243], v202 offset:53248
    v_mfma_f32_16x16x32_bf16 v[92:95], a[188:191], v[148:151], v[92:95]
    v_exp_f32 v139, v139
    s_cmp_eq_u32 s26, 16
    s_cbranch_scc1 L_tailB
L_entryB3:
    v_mfma_f32_16x16x32_bf16 v[144:147], a[64:67], a[16:19], v[164:167]
    v_perm_b32 v133, v139, v138, s27
    ds_read_b64_tr_b16 a[244:245], v202 offset:57344
    buffer_load_dwordx4 v99, s[4:7], s22 offen offset:3072 sc0 sc1 nt lds
    v_mfma_f32_16x16x32_bf16 v[144:147], a[68:71], a[20:23], v[144:147]
    v_exp_f32 v140, v140
    s_add_u32 m0, s24, 8192
    ds_read_b64_tr_b16 a[246:247], v202 offset:61440
    v_mfma_f32_16x16x32_bf16 v[144:147], a[72:75], a[24:27], v[144:147]
    ds_read_b64_tr_b16 a[248:249], v203 offset:49152
    v_mfma_f32_16x16x32_bf16 v[144:147], a[76:79], a[28:31], v[144:147]
    v_exp_f32 v141, v141
    buffer_load_dwordx4 v100, s[4:7], s22 offen offset:0 sc0 sc1 nt lds
    ds_read_b64_tr_b16 a[250:251], v203 offset:53248
    v_mfma_f32_16x16x32_bf16 v[148:151], a[80:83], a[16:19], v[164:167]
    v_perm_b32 v134, v141, v140, s27
    v_mfma_f32_16x16x32_bf16 v[148:151], a[84:87], a[20:23], v[148:151]
    v_exp_f32 v142, v142
    ds_read_b64_tr_b16 a[252:253], v203 offset:57344
    v_mfma_f32_16x16x32_bf16 v[148:151], a[88:91], a[24:27], v[148:151]
    buffer_load_dwordx4 v101, s[4:7], s22 offen offset:1024 sc0 sc1 nt lds
    v_mfma_f32_16x16x32_bf16 v[148:151], a[92:95], a[28:31], v[148:151]
    v_exp_f32 v143, v143
    ds_read_b64_tr_b16 a[254:255], v203 offset:61440
    s_waitcnt lgkmcnt(0)
    v_mfma_f32_16x16x32_bf16 v[152:155], a[96:99], a[16:19], v[164:167]
    v_perm_b32 v135, v143, v142, s27
    buffer_load_dwordx4 v102, s[4:7], s22 offen offset:2048 sc0 sc1 nt lds
    v_mfma_f32_16x16x32_bf16 v[152:155], a[100:103], a[20:23], v[152:155]
    v_xor_b32 v192, 0x10000, v192
    v_xor_b32 v193, 0x10000, v193
    v_mfma_f32_16x16x32_bf16 v[152:155], a[104:107], a[24:27], v[152:155]
    v_exp_f32 v144, v144
    v_mfma_f32_16x16x32_bf16 v[152:155], a[108:111], a[28:31], v[152:155]
    v_xor_b32 v194, 0x10000, v194
    v_xor_b32 v195, 0x10000, v195
    buffer_load_dwordx4 v103, s[4:7], s22 offen offset:3072 sc0 sc1 nt lds
    v_mfma_f32_16x16x32_bf16 v[156:159], a[112:115], a[16:19], v[164:167]
    v_exp_f32 v145, v145
    s_add_u32 m0, s24, 12288
    v_mfma_f32_16x16x32_bf16 v[156:159], a[116:119], a[20:23], v[156:159]
    v_perm_b32 v144, v145, v144, s27
    v_xor_b32 v196, 0x10000, v196
    v_mfma_f32_16x16x32_bf16 v[156:159], a[120:123], a[24:27], v[156:159]
    v_exp_f32 v146, v146
    buffer_load_dwordx4 v104, s[4:7], s22 offen offset:0 sc0 sc1 nt lds
    v_mfma_f32_16x16x32_bf16 v[156:159], a[124:127], a[28:31], v[156:159]
    v_xor_b32 v197, 0x10000, v197
    v_smfmac_f32_16x16x64_bf16 v[176:179], v[204:207], v[128:135], v220
    v_exp_f32 v147, v147
    v_mfma_f32_16x16x32_bf16 v[0:3], a[192:195], v[128:131], v[0:3]
    v_perm_b32 v145, v147, v146, s27
    v_xor_b32 v198, 0x10000, v198
    buffer_load_dwordx4 v105, s[4:7], s22 offen offset:1024 sc0 sc1 nt lds
    v_mfma_f32_16x16x32_bf16 v[0:3], a[196:199], v[132:135], v[0:3]
    v_exp_f32 v148, v148
    v_mfma_f32_16x16x32_bf16 v[4:7], a[200:203], v[128:131], v[4:7]
    v_xor_b32 v199, 0x10000, v199
    v_xor_b32 v200, 0x10000, v200
    v_mfma_f32_16x16x32_bf16 v[4:7], a[204:207], v[132:135], v[4:7]
    v_exp_f32 v149, v149
    buffer_load_dwordx4 v106, s[4:7], s22 offen offset:2048 sc0 sc1 nt lds
    v_mfma_f32_16x16x32_bf16 v[8:11], a[208:211], v[128:131], v[8:11]
    v_perm_b32 v146, v149, v148, s27
    v_xor_b32 v201, 0x10000, v201
    v_mfma_f32_16x16x32_bf16 v[8:11], a[212:215], v[132:135], v[8:11]
    v_exp_f32 v150, v150
    v_mfma_f32_16x16x32_bf16 v[12:15], a[216:219], v[128:131], v[12:15]
    v_xor_b32 v202, 0x10000, v202
    v_xor_b32 v203, 0x10000, v203
    buffer_load_dwordx4 v107, s[4:7], s22 offen offset:3072 sc0 sc1 nt lds
    s_add_u32 s22, s22, 16384
    v_mfma_f32_16x16x32_bf16 v[12:15], a[220:223], v[132:135], v[12:15]
    v_exp_f32 v151, v151
    s_add_u32 s24, s24, 32768
    v_mfma_f32_16x16x32_bf16 v[16:19], a[224:227], v[128:131], v[16:19]
    v_perm_b32 v147, v151, v150, s27
    s_and_b32 s24, s24, 0x1ffff
    v_mfma_f32_16x16x32_bf16 v[16:19], a[228:231], v[132:135], v[16:19]
    v_exp_f32 v152, v152
    v_mfma_f32_16x16x32_bf16 v[20:23], a[232:235], v[128:131], v[20:23]
    v_mfma_f32_16x16x32_bf16 v[20:23], a[236:239], v[132:135], v[20:23]
    v_exp_f32 v153, v153
    v_mfma_f32_16x16x32_bf16 v[24:27], a[240:243], v[128:131], v[24:27]
    v_perm_b32 v148, v153, v152, s27
    v_mfma_f32_16x16x32_bf16 v[24:27], a[244:247], v[132:135], v[24:27]
    v_exp_f32 v154, v154
    v_mfma_f32_16x16x32_bf16 v[28:31], a[248:251], v[128:131], v[28:31]
    v_mfma_f32_16x16x32_bf16 v[28:31], a[252:255], v[132:135], v[28:31]
    v_exp_f32 v155, v155
    s_waitcnt vmcnt(48)
    s_barrier
    v_mfma_f32_16x16x32_bf16 v[128:131], a[64:67], a[32:35], v[168:171]
    v_perm_b32 v149, v155, v154, s27
    ds_read_b128 a[64:67], v192 offset:0
    s_add_u32 m0, s25, 0
    v_mfma_f32_16x16x32_bf16 v[128:131], a[68:71], a[36:39], v[128:131]
    v_exp_f32 v156, v156
    buffer_load_dwordx4 v212, s[8:11], s23 offen offset:0 sc0 sc1 nt lds
    ds_read_b128 a[68:71], v193 offset:0
    v_mfma_f32_16x16x32_bf16 v[128:131], a[72:75], a[40:43], v[128:131]
    v_mfma_f32_16x16x32_bf16 v[128:131], a[76:79], a[44:47], v[128:131]
    v_exp_f32 v157, v157
    buffer_load_dwordx4 v213, s[8:11], s23 offen offset:1024 sc0 sc1 nt lds
    ds_read_b128 a[72:75], v194 offset:0
    v_mfma_f32_16x16x32_bf16 v[132:135], a[80:83], a[32:35], v[168:171]
    v_perm_b32 v150, v157, v156, s27
    v_mfma_f32_16x16x32_bf16 v[132:135], a[84:87], a[36:39], v[132:135]
    v_exp_f32 v158, v158
    ds_read_b128 a[76:79], v195 offset:0
    v_mfma_f32_16x16x32_bf16 v[132:135], a[88:91], a[40:43], v[132:135]
    buffer_load_dwordx4 v212, s[8:11], s23 offen offset:2048 sc0 sc1 nt lds
    v_mfma_f32_16x16x32_bf16 v[132:135], a[92:95], a[44:47], v[132:135]
    v_exp_f32 v159, v159
    ds_read_b128 a[80:83], v192 offset:4096
    v_mfma_f32_16x16x32_bf16 v[136:139], a[96:99], a[32:35], v[168:171]
    v_perm_b32 v151, v159, v158, s27
    v_mfma_f32_16x16x32_bf16 v[136:139], a[100:103], a[36:39], v[136:139]
    ds_read_b64_tr_b16 a[128:129], v196 offset:16384
    ds_read_b64_tr_b16 a[130:131], v196 offset:20480
    buffer_load_dwordx4 v213, s[8:11], s23 offen offset:3072 sc0 sc1 nt lds
    v_mfma_f32_16x16x32_bf16 v[136:139], a[104:107], a[40:43], v[136:139]
    v_exp_f32 v128, v128
    s_add_u32 m0, s25, 4096
    ds_read_b128 a[84:87], v193 offset:4096
    v_mfma_f32_16x16x32_bf16 v[136:139], a[108:111], a[44:47], v[136:139]
    v_mfma_f32_16x16x32_bf16 v[140:143], a[112:115], a[32:35], v[168:171]
    v_exp_f32 v129, v129
    buffer_load_dwordx4 v108, s[8:11], s23 offen offset:0 sc0 sc1 nt lds
    ds_read_b128 a[88:91], v194 offset:4096
    v_mfma_f32_16x16x32_bf16 v[140:143], a[116:119], a[36:39], v[140:143]
    v_perm_b32 v128, v129, v128, s27
    v_mfma_f32_16x16x32_bf16 v[140:143], a[120:123], a[40:43], v[140:143]
    v_exp_f32 v130, v130
    ds_read_b128 a[92:95], v195 offset:4096
    s_waitcnt lgkmcnt(0)
    v_mfma_f32_16x16x32_bf16 v[140:143], a[124:127], a[44:47], v[140:143]
    buffer_load_dwordx4 v109, s[8:11], s23 offen offset:1024 sc0 sc1 nt lds
    v_smfmac_f32_16x16x64_bf16 v[180:183], v[204:207], v[144:151], v220
    v_exp_f32 v131, v131
    ds_read_b128 a[96:99], v192 offset:8192
    v_mfma_f32_16x16x32_bf16 v[32:35], a[192:195], v[144:147], v[32:35]
    v_perm_b32 v129, v131, v130, s27
    v_mfma_f32_16x16x32_bf16 v[32:35], a[196:199], v[148:151], v[32:35]
    v_exp_f32 v132, v132
    buffer_load_dwordx4 v108, s[8:11], s23 offen offset:2048 sc0 sc1 nt lds
    ds_read_b128 a[100:103], v193 offset:8192
    v_mfma_f32_16x16x32_bf16 v[36:39], a[200:203], v[144:147], v[36:39]
    v_mfma_f32_16x16x32_bf16 v[36:39], a[204:207], v[148:151], v[36:39]
    v_exp_f32 v133, v133
    buffer_load_dwordx4 v109, s[8:11], s23 offen offset:3072 sc0 sc1 nt lds
    ds_read_b128 a[104:107], v194 offset:8192
    v_mfma_f32_16x16x32_bf16 v[40:43], a[208:211], v[144:147], v[40:43]
    v_perm_b32 v130, v133, v132, s27
    s_add_u32 m0, s25, 8192
    v_mfma_f32_16x16x32_bf16 v[40:43], a[212:215], v[148:151], v[40:43]
    v_exp_f32 v134, v134
    ds_read_b128 a[108:111], v195 offset:8192
    v_mfma_f32_16x16x32_bf16 v[44:47], a[216:219], v[144:147], v[44:47]
    buffer_load_dwordx4 v110, s[8:11], s23 offen offset:0 sc0 sc1 nt lds
    v_mfma_f32_16x16x32_bf16 v[44:47], a[220:223], v[148:151], v[44:47]
    v_exp_f32 v135, v135
    ds_read_b128 a[112:115], v192 offset:12288
    v_mfma_f32_16x16x32_bf16 v[48:51], a[224:227], v[144:147], v[48:51]
    v_perm_b32 v131, v135, v134, s27
    v_mfma_f32_16x16x32_bf16 v[48:51], a[228:231], v[148:151], v[48:51]
    v_exp_f32 v136, v136
    buffer_load_dwordx4 v111, s[8:11], s23 offen offset:1024 sc0 sc1 nt lds
    ds_read_b128 a[116:119], v193 offset:12288
    v_mfma_f32_16x16x32_bf16 v[52:55], a[232:235], v[144:147], v[52:55]
    v_mfma_f32_16x16x32_bf16 v[52:55], a[236:239], v[148:151], v[52:55]
    v_exp_f32 v137, v137
    ds_read_b128 a[120:123], v194 offset:12288
    v_mfma_f32_16x16x32_bf16 v[56:59], a[240:243], v[144:147], v[56:59]
    v_perm_b32 v132, v137, v136, s27
    buffer_load_dwordx4 v110, s[8:11], s23 offen offset:2048 sc0 sc1 nt lds
    v_mfma_f32_16x16x32_bf16 v[56:59], a[244:247], v[148:151], v[56:59]
    v_exp_f32 v138, v138
    ds_read_b128 a[124:127], v195 offset:12288
    s_waitcnt lgkmcnt(0)
    v_mfma_f32_16x16x32_bf16 v[60:63], a[248:251], v[144:147], v[60:63]
    v_mfma_f32_16x16x32_bf16 v[60:63], a[252:255], v[148:151], v[60:63]
    v_exp_f32 v139, v139
    v_mfma_f32_16x16x32_bf16 v[144:147], a[64:67], a[0:3], v[160:163]
    v_perm_b32 v133, v139, v138, s27
    ds_read_b64_tr_b16 a[132:133], v196 offset:24576
    buffer_load_dwordx4 v111, s[8:11], s23 offen offset:3072 sc0 sc1 nt lds
    v_mfma_f32_16x16x32_bf16 v[144:147], a[68:71], a[4:7], v[144:147]
    v_exp_f32 v140, v140
    s_add_u32 m0, s25, 12288
    ds_read_b64_tr_b16 a[134:135], v196 offset:28672
    v_mfma_f32_16x16x32_bf16 v[144:147], a[72:75], a[8:11], v[144:147]
    ds_read_b64_tr_b16 a[136:137], v197 offset:16384
    buffer_load_dwordx4 v112, s[8:11], s23 offen offset:0 sc0 sc1 nt lds
    v_mfma_f32_16x16x32_bf16 v[144:147], a[76:79], a[12:15], v[144:147]
    v_exp_f32 v141, v141
    ds_read_b64_tr_b16 a[138:139], v197 offset:20480
    v_mfma_f32_16x16x32_bf16 v[148:151], a[80:83], a[0:3], v[160:163]
    v_perm_b32 v134, v141, v140, s27
    buffer_load_dwordx4 v113, s[8:11], s23 offen offset:1024 sc0 sc1 nt lds
    v_mfma_f32_16x16x32_bf16 v[148:151], a[84:87], a[4:7], v[148:151]
    v_exp_f32 v142, v142
    ds_read_b64_tr_b16 a[140:141], v197 offset:24576
    v_mfma_f32_16x16x32_bf16 v[148:151], a[88:91], a[8:11], v[148:151]
    ds_read_b64_tr_b16 a[142:143], v197 offset:28672
    v_mfma_f32_16x16x32_bf16 v[148:151], a[92:95], a[12:15], v[148:151]
    v_exp_f32 v143, v143
    buffer_load_dwordx4 v112, s[8:11], s23 offen offset:2048 sc0 sc1 nt lds
    ds_read_b64_tr_b16 a[144:145], v198 offset:16384
    v_mfma_f32_16x16x32_bf16 v[152:155], a[96:99], a[0:3], v[160:163]
    v_perm_b32 v135, v143, v142, s27
    v_mfma_f32_16x16x32_bf16 v[152:155], a[100:103], a[4:7], v[152:155]
    ds_read_b64_tr_b16 a[146:147], v198 offset:20480
    ds_read_b64_tr_b16 a[148:149], v198 offset:24576
    v_mfma_f32_16x16x32_bf16 v[152:155], a[104:107], a[8:11], v[152:155]
    v_exp_f32 v144, v144
    buffer_load_dwordx4 v113, s[8:11], s23 offen offset:3072 sc0 sc1 nt lds
    s_add_u32 s23, s23, 16384
    ds_read_b64_tr_b16 a[150:151], v198 offset:28672
    v_mfma_f32_16x16x32_bf16 v[152:155], a[108:111], a[12:15], v[152:155]
    s_add_u32 s25, s24, 16384
    s_add_u32 m0, s24, 0
    v_mfma_f32_16x16x32_bf16 v[156:159], a[112:115], a[0:3], v[160:163]
    v_exp_f32 v145, v145
    ds_read_b64_tr_b16 a[152:153], v199 offset:16384
    v_mfma_f32_16x16x32_bf16 v[156:159], a[116:119], a[4:7], v[156:159]
    v_perm_b32 v144, v145, v144, s27
    buffer_load_dwordx4 v208, s[4:7], s22 offen offset:0 sc0 sc1 nt lds
    v_mfma_f32_16x16x32_bf16 v[156:159], a[120:123], a[8:11], v[156:159]
    v_exp_f32 v146, v146
    ds_read_b64_tr_b16 a[154:155], v199 offset:20480
    v_mfma_f32_16x16x32_bf16 v[156:159], a[124:127], a[12:15], v[156:159]
    ds_read_b64_tr_b16 a[156:157], v199 offset:24576
    v_smfmac_f32_16x16x64_bf16 v[184:187], v[204:207], v[128:135], v220
    v_exp_f32 v147, v147
    buffer_load_dwordx4 v209, s[4:7], s22 offen offset:1024 sc0 sc1 nt lds
    ds_read_b64_tr_b16 a[158:159], v199 offset:28672
    v_mfma_f32_16x16x32_bf16 v[64:67], a[192:195], v[128:131], v[64:67]
    v_perm_b32 v145, v147, v146, s27
    v_mfma_f32_16x16x32_bf16 v[64:67], a[196:199], v[132:135], v[64:67]
    v_exp_f32 v148, v148
    ds_read_b64_tr_b16 a[160:161], v200 offset:16384
    v_mfma_f32_16x16x32_bf16 v[68:71], a[200:203], v[128:131], v[68:71]
    ds_read_b64_tr_b16 a[162:163], v200 offset:20480
    buffer_load_dwordx4 v210, s[4:7], s22 offen offset:2048 sc0 sc1 nt lds
    v_mfma_f32_16x16x32_bf16 v[68:71], a[204:207], v[132:135], v[68:71]
    v_exp_f32 v149, v149
    ds_read_b64_tr_b16 a[164:165], v200 offset:24576
    v_mfma_f32_16x16x32_bf16 v[72:75], a[208:211], v[128:131], v[72:75]
    v_perm_b32 v146, v149, v148, s27
    v_mfma_f32_16x16x32_bf16 v[72:75], a[212:215], v[132:135], v[72:75]
    v_exp_f32 v150, v150
    buffer_load_dwordx4 v211, s[4:7], s22 offen offset:3072 sc0 sc1 nt lds
    ds_read_b64_tr_b16 a[166:167], v200 offset:28672
    v_mfma_f32_16x16x32_bf16 v[76:79], a[216:219], v[128:131], v[76:79]
    ds_read_b64_tr_b16 a[168:169], v201 offset:16384
    s_add_u32 m0, s24, 4096
    v_mfma_f32_16x16x32_bf16 v[76:79], a[220:223], v[132:135], v[76:79]
    v_exp_f32 v151, v151
    buffer_load_dwordx4 v96, s[4:7], s22 offen offset:0 sc0 sc1 nt lds
    v_mfma_f32_16x16x32_bf16 v[80:83], a[224:227], v[128:131], v[80:83]
    v_perm_b32 v147, v151, v150, s27
    v_mfma_f32_16x16x32_bf16 v[80:83], a[228:231], v[132:135], v[80:83]
    v_exp_f32 v152, v152
    ds_read_b64_tr_b16 a[170:171], v201 offset:20480
    v_mfma_f32_16x16x32_bf16 v[84:87], a[232:235], v[128:131], v[84:87]
    ds_read_b64_tr_b16 a[172:173], v201 offset:24576
    buffer_load_dwordx4 v97, s[4:7], s22 offen offset:1024 sc0 sc1 nt lds
    v_mfma_f32_16x16x32_bf16 v[84:87], a[236:239], v[132:135], v[84:87]
    v_exp_f32 v153, v153
    ds_read_b64_tr_b16 a[174:175], v201 offset:28672
    v_mfma_f32_16x16x32_bf16 v[88:91], a[240:243], v[128:131], v[88:91]
    v_perm_b32 v148, v153, v152, s27
    v_mfma_f32_16x16x32_bf16 v[88:91], a[244:247], v[132:135], v[88:91]
    v_exp_f32 v154, v154
    buffer_load_dwordx4 v98, s[4:7], s22 offen offset:2048 sc0 sc1 nt lds
    ds_read_b64_tr_b16 a[176:177], v202 offset:16384
    v_mfma_f32_16x16x32_bf16 v[92:95], a[248:251], v[128:131], v[92:95]
    ds_read_b64_tr_b16 a[178:179], v202 offset:20480
    v_mfma_f32_16x16x32_bf16 v[92:95], a[252:255], v[132:135], v[92:95]
    v_exp_f32 v155, v155
    v_mfma_f32_16x16x32_bf16 v[128:131], a[64:67], a[16:19], v[164:167]
    v_perm_b32 v149, v155, v154, s27
    ds_read_b64_tr_b16 a[180:181], v202 offset:24576
    buffer_load_dwordx4 v99, s[4:7], s22 offen offset:3072 sc0 sc1 nt lds
    v_mfma_f32_16x16x32_bf16 v[128:131], a[68:71], a[20:23], v[128:131]
    v_exp_f32 v156, v156
    s_add_u32 m0, s24, 8192
    ds_read_b64_tr_b16 a[182:183], v202 offset:28672
    v_mfma_f32_16x16x32_bf16 v[128:131], a[72:75], a[24:27], v[128:131]
    ds_read_b64_tr_b16 a[184:185], v203 offset:16384
    v_mfma_f32_16x16x32_bf16 v[128:131], a[76:79], a[28:31], v[128:131]
    v_exp_f32 v157, v157
    buffer_load_dwordx4 v100, s[4:7], s22 offen offset:0 sc0 sc1 nt lds
    ds_read_b64_tr_b16 a[186:187], v203 offset:20480
    v_mfma_f32_16x16x32_bf16 v[132:135], a[80:83], a[16:19], v[164:167]
    v_perm_b32 v150, v157, v156, s27
    v_mfma_f32_16x16x32_bf16 v[132:135], a[84:87], a[20:23], v[132:135]
    v_exp_f32 v158, v158
    ds_read_b64_tr_b16 a[188:189], v203 offset:24576
    v_mfma_f32_16x16x32_bf16 v[132:135], a[88:91], a[24:27], v[132:135]
    buffer_load_dwordx4 v101, s[4:7], s22 offen offset:1024 sc0 sc1 nt lds
    v_mfma_f32_16x16x32_bf16 v[132:135], a[92:95], a[28:31], v[132:135]
    v_exp_f32 v159, v159
    ds_read_b64_tr_b16 a[190:191], v203 offset:28672
    s_waitcnt lgkmcnt(0)
    v_mfma_f32_16x16x32_bf16 v[136:139], a[96:99], a[16:19], v[164:167]
    v_perm_b32 v151, v159, v158, s27
    buffer_load_dwordx4 v102, s[4:7], s22 offen offset:2048 sc0 sc1 nt lds
    v_mfma_f32_16x16x32_bf16 v[136:139], a[100:103], a[20:23], v[136:139]
    v_mfma_f32_16x16x32_bf16 v[136:139], a[104:107], a[24:27], v[136:139]
    v_exp_f32 v128, v128
    v_mfma_f32_16x16x32_bf16 v[136:139], a[108:111], a[28:31], v[136:139]
    buffer_load_dwordx4 v103, s[4:7], s22 offen offset:3072 sc0 sc1 nt lds
    s_add_u32 m0, s24, 12288
    v_mfma_f32_16x16x32_bf16 v[140:143], a[112:115], a[16:19], v[164:167]
    v_exp_f32 v129, v129
    v_mfma_f32_16x16x32_bf16 v[140:143], a[116:119], a[20:23], v[140:143]
    v_perm_b32 v128, v129, v128, s27
    v_mfma_f32_16x16x32_bf16 v[140:143], a[120:123], a[24:27], v[140:143]
    v_exp_f32 v130, v130
    buffer_load_dwordx4 v104, s[4:7], s22 offen offset:0 sc0 sc1 nt lds
    v_mfma_f32_16x16x32_bf16 v[140:143], a[124:127], a[28:31], v[140:143]
    v_smfmac_f32_16x16x64_bf16 v[176:179], v[204:207], v[144:151], v220
    v_exp_f32 v131, v131
    v_mfma_f32_16x16x32_bf16 v[0:3], a[128:131], v[144:147], v[0:3]
    v_perm_b32 v129, v131, v130, s27
    buffer_load_dwordx4 v105, s[4:7], s22 offen offset:1024 sc0 sc1 nt lds
    v_mfma_f32_16x16x32_bf16 v[0:3], a[132:135], v[148:151], v[0:3]
    v_exp_f32 v132, v132
    v_mfma_f32_16x16x32_bf16 v[4:7], a[136:139], v[144:147], v[4:7]
    v_mfma_f32_16x16x32_bf16 v[4:7], a[140:143], v[148:151], v[4:7]
    v_exp_f32 v133, v133
    buffer_load_dwordx4 v106, s[4:7], s22 offen offset:2048 sc0 sc1 nt lds
    v_mfma_f32_16x16x32_bf16 v[8:11], a[144:147], v[144:147], v[8:11]
    v_perm_b32 v130, v133, v132, s27
    v_mfma_f32_16x16x32_bf16 v[8:11], a[148:151], v[148:151], v[8:11]
    v_exp_f32 v134, v134
    v_mfma_f32_16x16x32_bf16 v[12:15], a[152:155], v[144:147], v[12:15]
    buffer_load_dwordx4 v107, s[4:7], s22 offen offset:3072 sc0 sc1 nt lds
    s_add_u32 s22, s22, 16384
    v_mfma_f32_16x16x32_bf16 v[12:15], a[156:159], v[148:151], v[12:15]
    v_exp_f32 v135, v135
    s_add_u32 s24, s24, 32768
    v_mfma_f32_16x16x32_bf16 v[16:19], a[160:163], v[144:147], v[16:19]
    v_perm_b32 v131, v135, v134, s27
    s_and_b32 s24, s24, 0x1ffff
    v_mfma_f32_16x16x32_bf16 v[16:19], a[164:167], v[148:151], v[16:19]
    v_exp_f32 v136, v136
    v_mfma_f32_16x16x32_bf16 v[20:23], a[168:171], v[144:147], v[20:23]
    v_mfma_f32_16x16x32_bf16 v[20:23], a[172:175], v[148:151], v[20:23]
    v_exp_f32 v137, v137
    v_mfma_f32_16x16x32_bf16 v[24:27], a[176:179], v[144:147], v[24:27]
    v_perm_b32 v132, v137, v136, s27
    v_mfma_f32_16x16x32_bf16 v[24:27], a[180:183], v[148:151], v[24:27]
    v_exp_f32 v138, v138
    v_mfma_f32_16x16x32_bf16 v[28:31], a[184:187], v[144:147], v[28:31]
    v_mfma_f32_16x16x32_bf16 v[28:31], a[188:191], v[148:151], v[28:31]
    v_exp_f32 v139, v139
    s_cmp_lt_u32 s26, s65
    s_cbranch_scc1 L_evenB3
    s_branch L_evenB2
L_slow:
    s_waitcnt vmcnt(0) lgkmcnt(0)
    s_lshl_b32 s38, s20, 13
    s_add_u32 s24, s38, 131072
    v_and_b32 v192, 0xffff, v192
    v_add_u32 v192, s24, v192
    v_and_b32 v193, 0xffff, v193
    v_add_u32 v193, s24, v193
    v_and_b32 v194, 0xffff, v194
    v_add_u32 v194, s24, v194
    v_and_b32 v195, 0xffff, v195
    v_add_u32 v195, s24, v195
    v_and_b32 v196, 0xffff, v196
    v_add_u32 v196, s24, v196
    v_and_b32 v197, 0xffff, v197
    v_add_u32 v197, s24, v197
    v_and_b32 v198, 0xffff, v198
    v_add_u32 v198, s24, v198
    v_and_b32 v199, 0xffff, v199
    v_add_u32 v199, s24, v199
    v_and_b32 v200, 0xffff, v200
    v_add_u32 v200, s24, v200
    v_and_b32 v201, 0xffff, v201
    v_add_u32 v201, s24, v201
    v_and_b32 v202, 0xffff, v202
    v_add_u32 v202, s24, v202
    v_and_b32 v203, 0xffff, v203
    v_add_u32 v203, s24, v203
    v_mov_b32 v0, 0
    v_mov_b32 v1, 0
    v_mov_b32 v2, 0
    v_mov_b32 v3, 0
    v_mov_b32 v4, 0
    v_mov_b32 v5, 0
    v_mov_b32 v6, 0
    v_mov_b32 v7, 0
    v_mov_b32 v8, 0
    v_mov_b32 v9, 0
    v_mov_b32 v10, 0
    v_mov_b32 v11, 0
    v_mov_b32 v12, 0
    v_mov_b32 v13, 0
    v_mov_b32 v14, 0
    v_mov_b32 v15, 0
    v_mov_b32 v16, 0
    v_mov_b32 v17, 0
    v_mov_b32 v18, 0
    v_mov_b32 v19, 0
    v_mov_b32 v20, 0
    v_mov_b32 v21, 0
    v_mov_b32 v22, 0
    v_mov_b32 v23, 0
    v_mov_b32 v24, 0
    v_mov_b32 v25, 0
    v_mov_b32 v26, 0
    v_mov_b32 v27, 0
    v_mov_b32 v28, 0
    v_mov_b32 v29, 0
    v_mov_b32 v30, 0
    v_mov_b32 v31, 0
    v_mov_b32 v32, 0
    v_mov_b32 v33, 0
    v_mov_b32 v34, 0
    v_mov_b32 v35, 0
    v_mov_b32 v36, 0
    v_mov_b32 v37, 0
    v_mov_b32 v38, 0
    v_mov_b32 v39, 0
    v_mov_b32 v40, 0
    v_mov_b32 v41, 0
    v_mov_b32 v42, 0
    v_mov_b32 v43, 0
    v_mov_b32 v44, 0
    v_mov_b32 v45, 0
    v_mov_b32 v46, 0
    v_mov_b32 v47, 0
    v_mov_b32 v48, 0
    v_mov_b32 v49, 0
    v_mov_b32 v50, 0
    v_mov_b32 v51, 0
    v_mov_b32 v52, 0
    v_mov_b32 v53, 0
    v_mov_b32 v54, 0
    v_mov_b32 v55, 0
    v_mov_b32 v56, 0
    v_mov_b32 v57, 0
    v_mov_b32 v58, 0
    v_mov_b32 v59, 0
    v_mov_b32 v60, 0
    v_mov_b32 v61, 0
    v_mov_b32 v62, 0
    v_mov_b32 v63, 0
    v_mov_b32 v64, 0
    v_mov_b32 v65, 0
    v_mov_b32 v66, 0
    v_mov_b32 v67, 0
    v_mov_b32 v68, 0
    v_mov_b32 v69, 0
    v_mov_b32 v70, 0
    v_mov_b32 v71, 0
    v_mov_b32 v72, 0
    v_mov_b32 v73, 0
    v_mov_b32 v74, 0
    v_mov_b32 v75, 0
    v_mov_b32 v76, 0
    v_mov_b32 v77, 0
    v_mov_b32 v78, 0
    v_mov_b32 v79, 0
    v_mov_b32 v80, 0
    v_mov_b32 v81, 0
    v_mov_b32 v82, 0
    v_mov_b32 v83, 0
    v_mov_b32 v84, 0
    v_mov_b32 v85, 0
    v_mov_b32 v86, 0
    v_mov_b32 v87, 0
    v_mov_b32 v88, 0
    v_mov_b32 v89, 0
    v_mov_b32 v90, 0
    v_mov_b32 v91, 0
    v_mov_b32 v92, 0
    v_mov_b32 v93, 0
    v_mov_b32 v94, 0
    v_mov_b32 v95, 0
    v_mov_b32 v96, 0
    v_mov_b32 v97, 0
    v_mov_b32 v98, 0
    v_mov_b32 v99, 0
    v_mov_b32 v100, 0
    v_mov_b32 v101, 0
    v_mov_b32 v102, 0
    v_mov_b32 v103, 0
    v_mov_b32 v104, 0
    v_mov_b32 v105, 0
    v_mov_b32 v106, 0
    v_mov_b32 v107, 0
    v_mov_b32 v108, 0
    v_mov_b32 v109, 0
    v_mov_b32 v110, 0
    v_mov_b32 v111, 0
    v_mov_b32 v112, 0
    v_mov_b32 v113, 0
    v_mov_b32 v114, 0
    v_mov_b32 v115, 0
    v_mov_b32 v116, 0
    v_mov_b32 v117, 0
    v_mov_b32 v118, 0
    v_mov_b32 v119, 0
    v_mov_b32 v120, 0
    v_mov_b32 v121, 0
    v_mov_b32 v122, 0
    v_mov_b32 v123, 0
    v_mov_b32 v124, 0
    v_mov_b32 v125, 0
    v_mov_b32 v126, 0
    v_mov_b32 v127, 0
    v_mov_b32 v176, 0
    v_mov_b32 v177, 0
    v_mov_b32 v178, 0
    v_mov_b32 v179, 0
    v_mov_b32 v180, 0
    v_mov_b32 v181, 0
    v_mov_b32 v182, 0
    v_mov_b32 v183, 0
    v_mov_b32 v184, 0
    v_mov_b32 v185, 0
    v_mov_b32 v186, 0
    v_mov_b32 v187, 0
    v_mov_b32 v188, 0
    v_mov_b32 v189, 0
    v_mov_b32 v190, 0
    v_mov_b32 v191, 0
    v_mov_b32 v224, 0xff800000
    v_mov_b32 v225, 0xff800000
    v_mov_b32 v226, 0xff800000
    v_mov_b32 v227, 0xff800000
    s_mov_b32 s22, 0
L_slow_loop:
    s_add_u32 m0, s24, 0
    s_add_u32 s38, s22, 0
    buffer_load_dwordx4 v208, s[4:7], s38 offen offset:0 sc0 sc1 nt lds
    buffer_load_dwordx4 v209, s[4:7], s38 offen offset:1024 sc0 sc1 nt lds
    buffer_load_dwordx4 v210, s[4:7], s38 offen offset:2048 sc0 sc1 nt lds
    buffer_load_dwordx4 v211, s[4:7], s38 offen offset:3072 sc0 sc1 nt lds
    s_add_u32 m0, s24, 4096
    s_add_u32 s38, s22, 4096
    buffer_load_dwordx4 v208, s[4:7], s38 offen offset:0 sc0 sc1 nt lds
    buffer_load_dwordx4 v209, s[4:7], s38 offen offset:1024 sc0 sc1 nt lds
    buffer_load_dwordx4 v210, s[4:7], s38 offen offset:2048 sc0 sc1 nt lds
    buffer_load_dwordx4 v211, s[4:7], s38 offen offset:3072 sc0 sc1 nt lds
    s_waitcnt vmcnt(0)
    ds_read_b128 a[64:67], v192 offset:0
    ds_read_b128 a[68:71], v193 offset:0
    ds_read_b128 a[72:75], v194 offset:0
    ds_read_b128 a[76:79], v195 offset:0
    ds_read_b128 a[80:83], v192 offset:4096
    ds_read_b128 a[84:87], v193 offset:4096
    ds_read_b128 a[88:91], v194 offset:4096
    ds_read_b128 a[92:95], v195 offset:4096
    s_waitcnt lgkmcnt(0)
    s_add_u32 m0, s24, 0
    s_add_u32 s38, s22, 0
    buffer_load_dwordx4 v212, s[8:11], s38 offen offset:0 sc0 sc1 nt lds
    buffer_load_dwordx4 v213, s[8:11], s38 offen offset:1024 sc0 sc1 nt lds
    buffer_load_dwordx4 v212, s[8:11], s38 offen offset:2048 sc0 sc1 nt lds
    buffer_load_dwordx4 v213, s[8:11], s38 offen offset:3072 sc0 sc1 nt lds
    s_add_u32 m0, s24, 4096
    s_add_u32 s38, s22, 4096
    buffer_load_dwordx4 v212, s[8:11], s38 offen offset:0 sc0 sc1 nt lds
    buffer_load_dwordx4 v213, s[8:11], s38 offen offset:1024 sc0 sc1 nt lds
    buffer_load_dwordx4 v212, s[8:11], s38 offen offset:2048 sc0 sc1 nt lds
    buffer_load_dwordx4 v213, s[8:11], s38 offen offset:3072 sc0 sc1 nt lds
    s_waitcnt vmcnt(0)
    ds_read_b64_tr_b16 a[128:129], v196 offset:0
    ds_read_b64_tr_b16 a[130:131], v196 offset:4096
    ds_read_b64_tr_b16 a[132:133], v197 offset:0
    ds_read_b64_tr_b16 a[134:135], v197 offset:4096
    ds_read_b64_tr_b16 a[136:137], v198 offset:0
    ds_read_b64_tr_b16 a[138:139], v198 offset:4096
    ds_read_b64_tr_b16 a[140:141], v199 offset:0
    ds_read_b64_tr_b16 a[142:143], v199 offset:4096
    ds_read_b64_tr_b16 a[144:145], v200 offset:0
    ds_read_b64_tr_b16 a[146:147], v200 offset:4096
    ds_read_b64_tr_b16 a[148:149], v201 offset:0
    ds_read_b64_tr_b16 a[150:151], v201 offset:4096
    ds_read_b64_tr_b16 a[152:153], v202 offset:0
    ds_read_b64_tr_b16 a[154:155], v202 offset:4096
    ds_read_b64_tr_b16 a[156:157], v203 offset:0
    ds_read_b64_tr_b16 a[158:159], v203 offset:4096
    s_waitcnt lgkmcnt(0)
    v_mfma_f32_16x16x32_bf16 v[128:131], a[64:67], a[0:3], 0
    v_mfma_f32_16x16x32_bf16 v[128:131], a[68:71], a[4:7], v[128:131]
    v_mfma_f32_16x16x32_bf16 v[128:131], a[72:75], a[8:11], v[128:131]
    v_mfma_f32_16x16x32_bf16 v[128:131], a[76:79], a[12:15], v[128:131]
    v_mfma_f32_16x16x32_bf16 v[132:135], a[80:83], a[0:3], 0
    v_mfma_f32_16x16x32_bf16 v[132:135], a[84:87], a[4:7], v[132:135]
    v_mfma_f32_16x16x32_bf16 v[132:135], a[88:91], a[8:11], v[132:135]
    v_mfma_f32_16x16x32_bf16 v[132:135], a[92:95], a[12:15], v[132:135]
    v_mfma_f32_16x16x32_bf16 v[136:139], a[64:67], a[16:19], 0
    v_mfma_f32_16x16x32_bf16 v[136:139], a[68:71], a[20:23], v[136:139]
    v_mfma_f32_16x16x32_bf16 v[136:139], a[72:75], a[24:27], v[136:139]
    v_mfma_f32_16x16x32_bf16 v[136:139], a[76:79], a[28:31], v[136:139]
    v_mfma_f32_16x16x32_bf16 v[140:143], a[80:83], a[16:19], 0
    v_mfma_f32_16x16x32_bf16 v[140:143], a[84:87], a[20:23], v[140:143]
    v_mfma_f32_16x16x32_bf16 v[140:143], a[88:91], a[24:27], v[140:143]
    v_mfma_f32_16x16x32_bf16 v[140:143], a[92:95], a[28:31], v[140:143]
    v_mfma_f32_16x16x32_bf16 v[144:147], a[64:67], a[32:35], 0
    v_mfma_f32_16x16x32_bf16 v[144:147], a[68:71], a[36:39], v[144:147]
    v_mfma_f32_16x16x32_bf16 v[144:147], a[72:75], a[40:43], v[144:147]
    v_mfma_f32_16x16x32_bf16 v[144:147], a[76:79], a[44:47], v[144:147]
    v_mfma_f32_16x16x32_bf16 v[148:151], a[80:83], a[32:35], 0
    v_mfma_f32_16x16x32_bf16 v[148:151], a[84:87], a[36:39], v[148:151]
    v_mfma_f32_16x16x32_bf16 v[148:151], a[88:91], a[40:43], v[148:151]
    v_mfma_f32_16x16x32_bf16 v[148:151], a[92:95], a[44:47], v[148:151]
    v_mfma_f32_16x16x32_bf16 v[152:155], a[64:67], a[48:51], 0
    v_mfma_f32_16x16x32_bf16 v[152:155], a[68:71], a[52:55], v[152:155]
    v_mfma_f32_16x16x32_bf16 v[152:155], a[72:75], a[56:59], v[152:155]
    v_mfma_f32_16x16x32_bf16 v[152:155], a[76:79], a[60:63], v[152:155]
    v_mfma_f32_16x16x32_bf16 v[156:159], a[80:83], a[48:51], 0
    v_mfma_f32_16x16x32_bf16 v[156:159], a[84:87], a[52:55], v[156:159]
    v_mfma_f32_16x16x32_bf16 v[156:159], a[88:91], a[56:59], v[156:159]
    v_mfma_f32_16x16x32_bf16 v[156:159], a[92:95], a[60:63], v[156:159]
    s_nop 7
    v_max3_f32 v228, v224, v128, v129
    v_max3_f32 v228, v228, v130, v131
    v_max3_f32 v228, v228, v132, v133
    v_max3_f32 v228, v228, v134, v135
    v_mov_b32 v229, v228
    s_nop 1
    v_permlane32_swap_b32 v228, v229
    v_max_f32 v228, v228, v229
    v_mov_b32 v229, v228
    s_nop 1
    v_permlane16_swap_b32 v228, v229
    v_max_f32 v228, v228, v229
    v_sub_f32 v229, v224, v228
    v_exp_f32 v229, v229
    v_mov_b32 v224, v228
    v_sub_f32 v128, v128, v228
    v_sub_f32 v129, v129, v228
    v_sub_f32 v130, v130, v228
    v_sub_f32 v131, v131, v228
    v_sub_f32 v132, v132, v228
    v_sub_f32 v133, v133, v228
    v_sub_f32 v134, v134, v228
    v_sub_f32 v135, v135, v228
    v_exp_f32 v128, v128
    v_exp_f32 v129, v129
    v_exp_f32 v130, v130
    v_exp_f32 v131, v131
    v_exp_f32 v132, v132
    v_exp_f32 v133, v133
    v_exp_f32 v134, v134
    v_exp_f32 v135, v135
    v_mul_f32 v0, v0, v229
    v_mul_f32 v1, v1, v229
    v_mul_f32 v2, v2, v229
    v_mul_f32 v3, v3, v229
    v_mul_f32 v4, v4, v229
    v_mul_f32 v5, v5, v229
    v_mul_f32 v6, v6, v229
    v_mul_f32 v7, v7, v229
    v_mul_f32 v8, v8, v229
    v_mul_f32 v9, v9, v229
    v_mul_f32 v10, v10, v229
    v_mul_f32 v11, v11, v229
    v_mul_f32 v12, v12, v229
    v_mul_f32 v13, v13, v229
    v_mul_f32 v14, v14, v229
    v_mul_f32 v15, v15, v229
    v_mul_f32 v16, v16, v229
    v_mul_f32 v17, v17, v229
    v_mul_f32 v18, v18, v229
    v_mul_f32 v19, v19, v229
    v_mul_f32 v20, v20, v229
    v_mul_f32 v21, v21, v229
    v_mul_f32 v22, v22, v229
    v_mul_f32 v23, v23, v229
    v_mul_f32 v24, v24, v229
    v_mul_f32 v25, v25, v229
    v_mul_f32 v26, v26, v229
    v_mul_f32 v27, v27, v229
    v_mul_f32 v28, v28, v229
    v_mul_f32 v29, v29, v229
    v_mul_f32 v30, v30, v229
    v_mul_f32 v31, v31, v229
    v_mul_f32 v176, v176, v229
    v_cvt_pk_bf16_f32 v128, v128, v129
    v_cvt_pk_bf16_f32 v129, v130, v131
    v_cvt_pk_bf16_f32 v130, v132, v133
    v_cvt_pk_bf16_f32 v131, v134, v135
    v_max3_f32 v228, v225, v136, v137
    v_max3_f32 v228, v228, v138, v139
    v_max3_f32 v228, v228, v140, v141
    v_max3_f32 v228, v228, v142, v143
    v_mov_b32 v229, v228
    s_nop 1
    v_permlane32_swap_b32 v228, v229
    v_max_f32 v228, v228, v229
    v_mov_b32 v229, v228
    s_nop 1
    v_permlane16_swap_b32 v228, v229
    v_max_f32 v228, v228, v229
    v_sub_f32 v229, v225, v228
    v_exp_f32 v229, v229
    v_mov_b32 v225, v228
    v_sub_f32 v136, v136, v228
    v_sub_f32 v137, v137, v228
    v_sub_f32 v138, v138, v228
    v_sub_f32 v139, v139, v228
    v_sub_f32 v140, v140, v228
    v_sub_f32 v141, v141, v228
    v_sub_f32 v142, v142, v228
    v_sub_f32 v143, v143, v228
    v_exp_f32 v136, v136
    v_exp_f32 v137, v137
    v_exp_f32 v138, v138
    v_exp_f32 v139, v139
    v_exp_f32 v140, v140
    v_exp_f32 v141, v141
    v_exp_f32 v142, v142
    v_exp_f32 v143, v143
    v_mul_f32 v32, v32, v229
    v_mul_f32 v33, v33, v229
    v_mul_f32 v34, v34, v229
    v_mul_f32 v35, v35, v229
    v_mul_f32 v36, v36, v229
    v_mul_f32 v37, v37, v229
    v_mul_f32 v38, v38, v229
    v_mul_f32 v39, v39, v229
    v_mul_f32 v40, v40, v229
    v_mul_f32 v41, v41, v229
    v_mul_f32 v42, v42, v229
    v_mul_f32 v43, v43, v229
    v_mul_f32 v44, v44, v229
    v_mul_f32 v45, v45, v229
    v_mul_f32 v46, v46, v229
    v_mul_f32 v47, v47, v229
    v_mul_f32 v48, v48, v229
    v_mul_f32 v49, v49, v229
    v_mul_f32 v50, v50, v229
    v_mul_f32 v51, v51, v229
    v_mul_f32 v52, v52, v229
    v_mul_f32 v53, v53, v229
    v_mul_f32 v54, v54, v229
    v_mul_f32 v55, v55, v229
    v_mul_f32 v56, v56, v229
    v_mul_f32 v57, v57, v229
    v_mul_f32 v58, v58, v229
    v_mul_f32 v59, v59, v229
    v_mul_f32 v60, v60, v229
    v_mul_f32 v61, v61, v229
    v_mul_f32 v62, v62, v229
    v_mul_f32 v63, v63, v229
    v_mul_f32 v180, v180, v229
    v_cvt_pk_bf16_f32 v136, v136, v137
    v_cvt_pk_bf16_f32 v137, v138, v139
    v_cvt_pk_bf16_f32 v138, v140, v141
    v_cvt_pk_bf16_f32 v139, v142, v143
    v_max3_f32 v228, v226, v144, v145
    v_max3_f32 v228, v228, v146, v147
    v_max3_f32 v228, v228, v148, v149
    v_max3_f32 v228, v228, v150, v151
    v_mov_b32 v229, v228
    s_nop 1
    v_permlane32_swap_b32 v228, v229
    v_max_f32 v228, v228, v229
    v_mov_b32 v229, v228
    s_nop 1
    v_permlane16_swap_b32 v228, v229
    v_max_f32 v228, v228, v229
    v_sub_f32 v229, v226, v228
    v_exp_f32 v229, v229
    v_mov_b32 v226, v228
    v_sub_f32 v144, v144, v228
    v_sub_f32 v145, v145, v228
    v_sub_f32 v146, v146, v228
    v_sub_f32 v147, v147, v228
    v_sub_f32 v148, v148, v228
    v_sub_f32 v149, v149, v228
    v_sub_f32 v150, v150, v228
    v_sub_f32 v151, v151, v228
    v_exp_f32 v144, v144
    v_exp_f32 v145, v145
    v_exp_f32 v146, v146
    v_exp_f32 v147, v147
    v_exp_f32 v148, v148
    v_exp_f32 v149, v149
    v_exp_f32 v150, v150
    v_exp_f32 v151, v151
    v_mul_f32 v64, v64, v229
    v_mul_f32 v65, v65, v229
    v_mul_f32 v66, v66, v229
    v_mul_f32 v67, v67, v229
    v_mul_f32 v68, v68, v229
    v_mul_f32 v69, v69, v229
    v_mul_f32 v70, v70, v229
    v_mul_f32 v71, v71, v229
    v_mul_f32 v72, v72, v229
    v_mul_f32 v73, v73, v229
    v_mul_f32 v74, v74, v229
    v_mul_f32 v75, v75, v229
    v_mul_f32 v76, v76, v229
    v_mul_f32 v77, v77, v229
    v_mul_f32 v78, v78, v229
    v_mul_f32 v79, v79, v229
    v_mul_f32 v80, v80, v229
    v_mul_f32 v81, v81, v229
    v_mul_f32 v82, v82, v229
    v_mul_f32 v83, v83, v229
    v_mul_f32 v84, v84, v229
    v_mul_f32 v85, v85, v229
    v_mul_f32 v86, v86, v229
    v_mul_f32 v87, v87, v229
    v_mul_f32 v88, v88, v229
    v_mul_f32 v89, v89, v229
    v_mul_f32 v90, v90, v229
    v_mul_f32 v91, v91, v229
    v_mul_f32 v92, v92, v229
    v_mul_f32 v93, v93, v229
    v_mul_f32 v94, v94, v229
    v_mul_f32 v95, v95, v229
    v_mul_f32 v184, v184, v229
    v_cvt_pk_bf16_f32 v144, v144, v145
    v_cvt_pk_bf16_f32 v145, v146, v147
    v_cvt_pk_bf16_f32 v146, v148, v149
    v_cvt_pk_bf16_f32 v147, v150, v151
    v_max3_f32 v228, v227, v152, v153
    v_max3_f32 v228, v228, v154, v155
    v_max3_f32 v228, v228, v156, v157
    v_max3_f32 v228, v228, v158, v159
    v_mov_b32 v229, v228
    s_nop 1
    v_permlane32_swap_b32 v228, v229
    v_max_f32 v228, v228, v229
    v_mov_b32 v229, v228
    s_nop 1
    v_permlane16_swap_b32 v228, v229
    v_max_f32 v228, v228, v229
    v_sub_f32 v229, v227, v228
    v_exp_f32 v229, v229
    v_mov_b32 v227, v228
    v_sub_f32 v152, v152, v228
    v_sub_f32 v153, v153, v228
    v_sub_f32 v154, v154, v228
    v_sub_f32 v155, v155, v228
    v_sub_f32 v156, v156, v228
    v_sub_f32 v157, v157, v228
    v_sub_f32 v158, v158, v228
    v_sub_f32 v159, v159, v228
    v_exp_f32 v152, v152
    v_exp_f32 v153, v153
    v_exp_f32 v154, v154
    v_exp_f32 v155, v155
    v_exp_f32 v156, v156
    v_exp_f32 v157, v157
    v_exp_f32 v158, v158
    v_exp_f32 v159, v159
    v_mul_f32 v96, v96, v229
    v_mul_f32 v97, v97, v229
    v_mul_f32 v98, v98, v229
    v_mul_f32 v99, v99, v229
    v_mul_f32 v100, v100, v229
    v_mul_f32 v101, v101, v229
    v_mul_f32 v102, v102, v229
    v_mul_f32 v103, v103, v229
    v_mul_f32 v104, v104, v229
    v_mul_f32 v105, v105, v229
    v_mul_f32 v106, v106, v229
    v_mul_f32 v107, v107, v229
    v_mul_f32 v108, v108, v229
    v_mul_f32 v109, v109, v229
    v_mul_f32 v110, v110, v229
    v_mul_f32 v111, v111, v229
    v_mul_f32 v112, v112, v229
    v_mul_f32 v113, v113, v229
    v_mul_f32 v114, v114, v229
    v_mul_f32 v115, v115, v229
    v_mul_f32 v116, v116, v229
    v_mul_f32 v117, v117, v229
    v_mul_f32 v118, v118, v229
    v_mul_f32 v119, v119, v229
    v_mul_f32 v120, v120, v229
    v_mul_f32 v121, v121, v229
    v_mul_f32 v122, v122, v229
    v_mul_f32 v123, v123, v229
    v_mul_f32 v124, v124, v229
    v_mul_f32 v125, v125, v229
    v_mul_f32 v126, v126, v229
    v_mul_f32 v127, v127, v229
    v_mul_f32 v188, v188, v229
    v_cvt_pk_bf16_f32 v152, v152, v153
    v_cvt_pk_bf16_f32 v153, v154, v155
    v_cvt_pk_bf16_f32 v154, v156, v157
    v_cvt_pk_bf16_f32 v155, v158, v159
    s_nop 1
    v_mfma_f32_16x16x32_bf16 v[176:179], v[204:207], v[128:131], v[176:179]
    v_mfma_f32_16x16x32_bf16 v[0:3], a[128:131], v[128:131], v[0:3]
    v_mfma_f32_16x16x32_bf16 v[4:7], a[132:135], v[128:131], v[4:7]
    v_mfma_f32_16x16x32_bf16 v[8:11], a[136:139], v[128:131], v[8:11]
    v_mfma_f32_16x16x32_bf16 v[12:15], a[140:143], v[128:131], v[12:15]
    v_mfma_f32_16x16x32_bf16 v[16:19], a[144:147], v[128:131], v[16:19]
    v_mfma_f32_16x16x32_bf16 v[20:23], a[148:151], v[128:131], v[20:23]
    v_mfma_f32_16x16x32_bf16 v[24:27], a[152:155], v[128:131], v[24:27]
    v_mfma_f32_16x16x32_bf16 v[28:31], a[156:159], v[128:131], v[28:31]
    v_mfma_f32_16x16x32_bf16 v[180:183], v[204:207], v[136:139], v[180:183]
    v_mfma_f32_16x16x32_bf16 v[32:35], a[128:131], v[136:139], v[32:35]
    v_mfma_f32_16x16x32_bf16 v[36:39], a[132:135], v[136:139], v[36:39]
    v_mfma_f32_16x16x32_bf16 v[40:43], a[136:139], v[136:139], v[40:43]
    v_mfma_f32_16x16x32_bf16 v[44:47], a[140:143], v[136:139], v[44:47]
    v_mfma_f32_16x16x32_bf16 v[48:51], a[144:147], v[136:139], v[48:51]
    v_mfma_f32_16x16x32_bf16 v[52:55], a[148:151], v[136:139], v[52:55]
    v_mfma_f32_16x16x32_bf16 v[56:59], a[152:155], v[136:139], v[56:59]
    v_mfma_f32_16x16x32_bf16 v[60:63], a[156:159], v[136:139], v[60:63]
    v_mfma_f32_16x16x32_bf16 v[184:187], v[204:207], v[144:147], v[184:187]
    v_mfma_f32_16x16x32_bf16 v[64:67], a[128:131], v[144:147], v[64:67]
    v_mfma_f32_16x16x32_bf16 v[68:71], a[132:135], v[144:147], v[68:71]
    v_mfma_f32_16x16x32_bf16 v[72:75], a[136:139], v[144:147], v[72:75]
    v_mfma_f32_16x16x32_bf16 v[76:79], a[140:143], v[144:147], v[76:79]
    v_mfma_f32_16x16x32_bf16 v[80:83], a[144:147], v[144:147], v[80:83]
    v_mfma_f32_16x16x32_bf16 v[84:87], a[148:151], v[144:147], v[84:87]
    v_mfma_f32_16x16x32_bf16 v[88:91], a[152:155], v[144:147], v[88:91]
    v_mfma_f32_16x16x32_bf16 v[92:95], a[156:159], v[144:147], v[92:95]
    v_mfma_f32_16x16x32_bf16 v[188:191], v[204:207], v[152:155], v[188:191]
    v_mfma_f32_16x16x32_bf16 v[96:99], a[128:131], v[152:155], v[96:99]
    v_mfma_f32_16x16x32_bf16 v[100:103], a[132:135], v[152:155], v[100:103]
    v_mfma_f32_16x16x32_bf16 v[104:107], a[136:139], v[152:155], v[104:107]
    v_mfma_f32_16x16x32_bf16 v[108:111], a[140:143], v[152:155], v[108:111]
    v_mfma_f32_16x16x32_bf16 v[112:115], a[144:147], v[152:155], v[112:115]
    v_mfma_f32_16x16x32_bf16 v[116:119], a[148:151], v[152:155], v[116:119]
    v_mfma_f32_16x16x32_bf16 v[120:123], a[152:155], v[152:155], v[120:123]
    v_mfma_f32_16x16x32_bf16 v[124:127], a[156:159], v[152:155], v[124:127]
    s_add_u32 s22, s22, 8192
    s_cmp_lt_u32 s22, 0x80000
    s_cbranch_scc1 L_slow_loop
    s_nop 7
    v_and_b32 v228, 15, v214
    v_lshrrev_b32 v229, 4, v214
    v_lshlrev_b32 v228, 8, v228
    v_lshl_add_u32 v228, v229, 3, v228
    s_lshl_b32 s38, s20, 14
    v_rcp_f32 v230, v176
    s_nop 0
    v_mul_f32 v0, v0, v230
    v_mul_f32 v1, v1, v230
    v_mul_f32 v2, v2, v230
    v_mul_f32 v3, v3, v230
    v_cvt_pk_bf16_f32 v0, v0, v1
    v_cvt_pk_bf16_f32 v1, v2, v3
    buffer_store_dwordx2 v[0:1], v228, s[16:19], s38 offen offset:0
    v_mul_f32 v4, v4, v230
    v_mul_f32 v5, v5, v230
    v_mul_f32 v6, v6, v230
    v_mul_f32 v7, v7, v230
    v_cvt_pk_bf16_f32 v4, v4, v5
    v_cvt_pk_bf16_f32 v5, v6, v7
    buffer_store_dwordx2 v[4:5], v228, s[16:19], s38 offen offset:32
    v_mul_f32 v8, v8, v230
    v_mul_f32 v9, v9, v230
    v_mul_f32 v10, v10, v230
    v_mul_f32 v11, v11, v230
    v_cvt_pk_bf16_f32 v8, v8, v9
    v_cvt_pk_bf16_f32 v9, v10, v11
    buffer_store_dwordx2 v[8:9], v228, s[16:19], s38 offen offset:64
    v_mul_f32 v12, v12, v230
    v_mul_f32 v13, v13, v230
    v_mul_f32 v14, v14, v230
    v_mul_f32 v15, v15, v230
    v_cvt_pk_bf16_f32 v12, v12, v13
    v_cvt_pk_bf16_f32 v13, v14, v15
    buffer_store_dwordx2 v[12:13], v228, s[16:19], s38 offen offset:96
    v_mul_f32 v16, v16, v230
    v_mul_f32 v17, v17, v230
    v_mul_f32 v18, v18, v230
    v_mul_f32 v19, v19, v230
    v_cvt_pk_bf16_f32 v16, v16, v17
    v_cvt_pk_bf16_f32 v17, v18, v19
    buffer_store_dwordx2 v[16:17], v228, s[16:19], s38 offen offset:128
    v_mul_f32 v20, v20, v230
    v_mul_f32 v21, v21, v230
    v_mul_f32 v22, v22, v230
    v_mul_f32 v23, v23, v230
    v_cvt_pk_bf16_f32 v20, v20, v21
    v_cvt_pk_bf16_f32 v21, v22, v23
    buffer_store_dwordx2 v[20:21], v228, s[16:19], s38 offen offset:160
    v_mul_f32 v24, v24, v230
    v_mul_f32 v25, v25, v230
    v_mul_f32 v26, v26, v230
    v_mul_f32 v27, v27, v230
    v_cvt_pk_bf16_f32 v24, v24, v25
    v_cvt_pk_bf16_f32 v25, v26, v27
    buffer_store_dwordx2 v[24:25], v228, s[16:19], s38 offen offset:192
    v_mul_f32 v28, v28, v230
    v_mul_f32 v29, v29, v230
    v_mul_f32 v30, v30, v230
    v_mul_f32 v31, v31, v230
    v_cvt_pk_bf16_f32 v28, v28, v29
    v_cvt_pk_bf16_f32 v29, v30, v31
    buffer_store_dwordx2 v[28:29], v228, s[16:19], s38 offen offset:224
    s_add_u32 s38, s38, 4096
    v_rcp_f32 v230, v180
    s_nop 0
    v_mul_f32 v32, v32, v230
    v_mul_f32 v33, v33, v230
    v_mul_f32 v34, v34, v230
    v_mul_f32 v35, v35, v230
    v_cvt_pk_bf16_f32 v32, v32, v33
    v_cvt_pk_bf16_f32 v33, v34, v35
    buffer_store_dwordx2 v[32:33], v228, s[16:19], s38 offen offset:0
    v_mul_f32 v36, v36, v230
    v_mul_f32 v37, v37, v230
    v_mul_f32 v38, v38, v230
    v_mul_f32 v39, v39, v230
    v_cvt_pk_bf16_f32 v36, v36, v37
    v_cvt_pk_bf16_f32 v37, v38, v39
    buffer_store_dwordx2 v[36:37], v228, s[16:19], s38 offen offset:32
    v_mul_f32 v40, v40, v230
    v_mul_f32 v41, v41, v230
    v_mul_f32 v42, v42, v230
    v_mul_f32 v43, v43, v230
    v_cvt_pk_bf16_f32 v40, v40, v41
    v_cvt_pk_bf16_f32 v41, v42, v43
    buffer_store_dwordx2 v[40:41], v228, s[16:19], s38 offen offset:64
    v_mul_f32 v44, v44, v230
    v_mul_f32 v45, v45, v230
    v_mul_f32 v46, v46, v230
    v_mul_f32 v47, v47, v230
    v_cvt_pk_bf16_f32 v44, v44, v45
    v_cvt_pk_bf16_f32 v45, v46, v47
    buffer_store_dwordx2 v[44:45], v228, s[16:19], s38 offen offset:96
    v_mul_f32 v48, v48, v230
    v_mul_f32 v49, v49, v230
    v_mul_f32 v50, v50, v230
    v_mul_f32 v51, v51, v230
    v_cvt_pk_bf16_f32 v48, v48, v49
    v_cvt_pk_bf16_f32 v49, v50, v51
    buffer_store_dwordx2 v[48:49], v228, s[16:19], s38 offen offset:128
    v_mul_f32 v52, v52, v230
    v_mul_f32 v53, v53, v230
    v_mul_f32 v54, v54, v230
    v_mul_f32 v55, v55, v230
    v_cvt_pk_bf16_f32 v52, v52, v53
    v_cvt_pk_bf16_f32 v53, v54, v55
    buffer_store_dwordx2 v[52:53], v228, s[16:19], s38 offen offset:160
    v_mul_f32 v56, v56, v230
    v_mul_f32 v57, v57, v230
    v_mul_f32 v58, v58, v230
    v_mul_f32 v59, v59, v230
    v_cvt_pk_bf16_f32 v56, v56, v57
    v_cvt_pk_bf16_f32 v57, v58, v59
    buffer_store_dwordx2 v[56:57], v228, s[16:19], s38 offen offset:192
    v_mul_f32 v60, v60, v230
    v_mul_f32 v61, v61, v230
    v_mul_f32 v62, v62, v230
    v_mul_f32 v63, v63, v230
    v_cvt_pk_bf16_f32 v60, v60, v61
    v_cvt_pk_bf16_f32 v61, v62, v63
    buffer_store_dwordx2 v[60:61], v228, s[16:19], s38 offen offset:224
    s_add_u32 s38, s38, 4096
    v_rcp_f32 v230, v184
    s_nop 0
    v_mul_f32 v64, v64, v230
    v_mul_f32 v65, v65, v230
    v_mul_f32 v66, v66, v230
    v_mul_f32 v67, v67, v230
    v_cvt_pk_bf16_f32 v64, v64, v65
    v_cvt_pk_bf16_f32 v65, v66, v67
    buffer_store_dwordx2 v[64:65], v228, s[16:19], s38 offen offset:0
    v_mul_f32 v68, v68, v230
    v_mul_f32 v69, v69, v230
    v_mul_f32 v70, v70, v230
    v_mul_f32 v71, v71, v230
    v_cvt_pk_bf16_f32 v68, v68, v69
    v_cvt_pk_bf16_f32 v69, v70, v71
    buffer_store_dwordx2 v[68:69], v228, s[16:19], s38 offen offset:32
    v_mul_f32 v72, v72, v230
    v_mul_f32 v73, v73, v230
    v_mul_f32 v74, v74, v230
    v_mul_f32 v75, v75, v230
    v_cvt_pk_bf16_f32 v72, v72, v73
    v_cvt_pk_bf16_f32 v73, v74, v75
    buffer_store_dwordx2 v[72:73], v228, s[16:19], s38 offen offset:64
    v_mul_f32 v76, v76, v230
    v_mul_f32 v77, v77, v230
    v_mul_f32 v78, v78, v230
    v_mul_f32 v79, v79, v230
    v_cvt_pk_bf16_f32 v76, v76, v77
    v_cvt_pk_bf16_f32 v77, v78, v79
    buffer_store_dwordx2 v[76:77], v228, s[16:19], s38 offen offset:96
    v_mul_f32 v80, v80, v230
    v_mul_f32 v81, v81, v230
    v_mul_f32 v82, v82, v230
    v_mul_f32 v83, v83, v230
    v_cvt_pk_bf16_f32 v80, v80, v81
    v_cvt_pk_bf16_f32 v81, v82, v83
    buffer_store_dwordx2 v[80:81], v228, s[16:19], s38 offen offset:128
    v_mul_f32 v84, v84, v230
    v_mul_f32 v85, v85, v230
    v_mul_f32 v86, v86, v230
    v_mul_f32 v87, v87, v230
    v_cvt_pk_bf16_f32 v84, v84, v85
    v_cvt_pk_bf16_f32 v85, v86, v87
    buffer_store_dwordx2 v[84:85], v228, s[16:19], s38 offen offset:160
    v_mul_f32 v88, v88, v230
    v_mul_f32 v89, v89, v230
    v_mul_f32 v90, v90, v230
    v_mul_f32 v91, v91, v230
    v_cvt_pk_bf16_f32 v88, v88, v89
    v_cvt_pk_bf16_f32 v89, v90, v91
    buffer_store_dwordx2 v[88:89], v228, s[16:19], s38 offen offset:192
    v_mul_f32 v92, v92, v230
    v_mul_f32 v93, v93, v230
    v_mul_f32 v94, v94, v230
    v_mul_f32 v95, v95, v230
    v_cvt_pk_bf16_f32 v92, v92, v93
    v_cvt_pk_bf16_f32 v93, v94, v95
    buffer_store_dwordx2 v[92:93], v228, s[16:19], s38 offen offset:224
    s_add_u32 s38, s38, 4096
    v_rcp_f32 v230, v188
    s_nop 0
    v_mul_f32 v96, v96, v230
    v_mul_f32 v97, v97, v230
    v_mul_f32 v98, v98, v230
    v_mul_f32 v99, v99, v230
    v_cvt_pk_bf16_f32 v96, v96, v97
    v_cvt_pk_bf16_f32 v97, v98, v99
    buffer_store_dwordx2 v[96:97], v228, s[16:19], s38 offen offset:0
    v_mul_f32 v100, v100, v230
    v_mul_f32 v101, v101, v230
    v_mul_f32 v102, v102, v230
    v_mul_f32 v103, v103, v230
    v_cvt_pk_bf16_f32 v100, v100, v101
    v_cvt_pk_bf16_f32 v101, v102, v103
    buffer_store_dwordx2 v[100:101], v228, s[16:19], s38 offen offset:32
    v_mul_f32 v104, v104, v230
    v_mul_f32 v105, v105, v230
    v_mul_f32 v106, v106, v230
    v_mul_f32 v107, v107, v230
    v_cvt_pk_bf16_f32 v104, v104, v105
    v_cvt_pk_bf16_f32 v105, v106, v107
    buffer_store_dwordx2 v[104:105], v228, s[16:19], s38 offen offset:64
    v_mul_f32 v108, v108, v230
    v_mul_f32 v109, v109, v230
    v_mul_f32 v110, v110, v230
    v_mul_f32 v111, v111, v230
    v_cvt_pk_bf16_f32 v108, v108, v109
    v_cvt_pk_bf16_f32 v109, v110, v111
    buffer_store_dwordx2 v[108:109], v228, s[16:19], s38 offen offset:96
    v_mul_f32 v112, v112, v230
    v_mul_f32 v113, v113, v230
    v_mul_f32 v114, v114, v230
    v_mul_f32 v115, v115, v230
    v_cvt_pk_bf16_f32 v112, v112, v113
    v_cvt_pk_bf16_f32 v113, v114, v115
    buffer_store_dwordx2 v[112:113], v228, s[16:19], s38 offen offset:128
    v_mul_f32 v116, v116, v230
    v_mul_f32 v117, v117, v230
    v_mul_f32 v118, v118, v230
    v_mul_f32 v119, v119, v230
    v_cvt_pk_bf16_f32 v116, v116, v117
    v_cvt_pk_bf16_f32 v117, v118, v119
    buffer_store_dwordx2 v[116:117], v228, s[16:19], s38 offen offset:160
    v_mul_f32 v120, v120, v230
    v_mul_f32 v121, v121, v230
    v_mul_f32 v122, v122, v230
    v_mul_f32 v123, v123, v230
    v_cvt_pk_bf16_f32 v120, v120, v121
    v_cvt_pk_bf16_f32 v121, v122, v123
    buffer_store_dwordx2 v[120:121], v228, s[16:19], s38 offen offset:192
    v_mul_f32 v124, v124, v230
    v_mul_f32 v125, v125, v230
    v_mul_f32 v126, v126, v230
    v_mul_f32 v127, v127, v230
    v_cvt_pk_bf16_f32 v124, v124, v125
    v_cvt_pk_bf16_f32 v125, v126, v127
    buffer_store_dwordx2 v[124:125], v228, s[16:19], s38 offen offset:224
    s_add_u32 s38, s38, 4096
L_done:
L_end:
    s_endpgm
.section .rodata,"a"
.p2align 6
.amdhsa_kernel standalone__mha_softmax__near_ridge_kernel
  .amdhsa_next_free_vgpr 512
  .amdhsa_next_free_sgpr 102
  .amdhsa_accum_offset 256
  .amdhsa_group_segment_fixed_size 0
  .amdhsa_kernarg_size 48
  .amdhsa_user_sgpr_count 2
  .amdhsa_user_sgpr_kernarg_segment_ptr 1
  .amdhsa_system_sgpr_workgroup_id_x 1
.end_amdhsa_kernel
```
